```python
import torch

def _softmax(x, axis=-1):
    return torch.softmax(x, dim=axis)
def _gelu(x):
    return torch.nn.functional.gelu(x, approximate="tanh")
def _silu(x):
    return torch.nn.functional.silu(x)
def _sigmoid(x):
    return torch.sigmoid(x)
def _layernorm(x, axis=-1, eps=1e-5):
    m = x.mean(dim=axis, keepdim=True)
    v = x.var(dim=axis, keepdim=True, unbiased=False)
    return (x - m) / torch.sqrt(v + eps)
def _scatter_add(tgt, idx, src, axis=0):
    return tgt.clone().index_add_(axis, idx, src)
def _segment_sum(src, seg, n):
    out = torch.zeros((n,) + src.shape[1:], dtype=src.dtype)
    return out.index_add_(0, seg, src)
def _pad(x, pw):
    flat = tuple(v for pair in reversed(pw) for v in pair)
    return torch.nn.functional.pad(x, flat)

kernel_name = 'sequential_preLN__ssm_conv_s4d__swiglu_ffn__prompt'

def setup_inputs():

    _w = (lambda a: (lambda t: t.to(torch.bfloat16) if t.is_floating_point() else t)(torch.as_tensor(a)))
    def _A_setup():
        Bsz, L, D, N = 1, 2048, 448, 256
        return {
            "u": _w((lambda *s: torch.randn(*s, dtype=torch.bfloat16) * 0.05)(Bsz, L, D)),
            "log_A_real": _w((lambda *s: torch.randn(*s, dtype=torch.bfloat16) * 6.4)(D, N) * 0.5),
            "A_imag": _w((lambda *s: torch.randn(*s, dtype=torch.bfloat16) * 0.05)(D, N) * 3.14),
            "C_real": _w((lambda *s: torch.randn(*s, dtype=torch.bfloat16) * 0.05)(D, N) / N ** 0.5),
            "C_imag": _w((lambda *s: torch.randn(*s, dtype=torch.bfloat16) * 0.05)(D, N) / N ** 0.5),
            "log_dt": _w((lambda *s: torch.randn(*s, dtype=torch.bfloat16) * 0.05)(D) * 0.5 - 4.0),
            "D_skip": _w((lambda *s: torch.randn(*s, dtype=torch.bfloat16) * 0.05)(D)),
        }
    _A_in = _A_setup()

    def _B_setup():
        B, S, D, F = 1, 2048, 448, 1792
        return {
            "x": _w((lambda *s: torch.randn(*s, dtype=torch.bfloat16) * 0.05)(B, S, D)),
            "w_gate": _w((lambda *s: torch.randn(*s, dtype=torch.bfloat16) * 0.05)(D, F)),
            "w_up": _w((lambda *s: torch.randn(*s, dtype=torch.bfloat16) * 0.05)(D, F)),
            "w_down": _w((lambda *s: torch.randn(*s, dtype=torch.bfloat16) * 0.05)(F, D)),
        }
    _B_in = _B_setup()

    return {
        "A_u": _A_in["u"],
        "A_log_A_real": _A_in["log_A_real"],
        "A_A_imag": _A_in["A_imag"],
        "A_C_real": _A_in["C_real"],
        "A_C_imag": _A_in["C_imag"],
        "A_log_dt": _A_in["log_dt"],
        "A_D_skip": _A_in["D_skip"],
        "B_x": _B_in["x"],
        "B_w_gate": _B_in["w_gate"],
        "B_w_up": _B_in["w_up"],
        "B_w_down": _B_in["w_down"],
    }

def reference(A_u, A_log_A_real, A_A_imag, A_C_real, A_C_imag, A_log_dt, A_D_skip, B_x, B_w_gate, B_w_up, B_w_down):
    def _A_ref(u, log_A_real, A_imag, C_real, C_imag, log_dt, D_skip):
        L = u.shape[1]
        dt = torch.exp(log_dt)
        A = -torch.exp(log_A_real) + 1j * A_imag
        C = (C_real + 1j * C_imag) * dt[:, None]
        pos = (lambda x, dt: x.to(dt))(torch.arange(L), log_dt.dtype)
        P = torch.exp((A * dt[:, None])[:, :, None] * pos[None, None, :])
        K = 2.0 * torch.einsum("dn,dnl->dl", C, P).real
        L2 = 2 * L
        u_t = (lambda x, *d: x.permute(*d))(u, 0, 2, 1)
        Kf = (lambda x, *a, **k: torch.fft.rfft(x.float(), *a, **k))(K, L2)
        Uf = (lambda x, *a, **k: torch.fft.rfft(x.float(), *a, **k))(u_t, L2)
        y = (lambda x, *a, **k: torch.fft.irfft(x, *a, **k).to(torch.bfloat16))(Uf * Kf[None, :, :], L2)[:, :, :L]
        y = (lambda x, *d: x.permute(*d))(y, 0, 2, 1)
        return y + u * D_skip[None, None, :]

    def _B_ref(x, w_gate, w_up, w_down):
        g = _silu(x @ w_gate)
        u = x @ w_up
        return (g * u) @ w_down

    x = A_u
    h = x + _A_ref(_layernorm(x, axis=-1), A_log_A_real, A_A_imag, A_C_real, A_C_imag, A_log_dt, A_D_skip)
    h2 = h + _B_ref(_layernorm(h, axis=-1), B_w_gate, B_w_up, B_w_down)
    return h2
```

```asm
; @launch grid=(252,1,1) block=(256,1,1) lds=163840
.amdgcn_target "amdgcn-amd-amdhsa--gfx950"
.text
.globl sequential_preLN__ssm_conv_s4d__swiglu_ffn__prompt_kernel
.p2align 8
.type sequential_preLN__ssm_conv_s4d__swiglu_ffn__prompt_kernel,@function
sequential_preLN__ssm_conv_s4d__swiglu_ffn__prompt_kernel:
    s_cmp_ge_u32 s2, 252
    s_cbranch_scc1 L_end
    s_getpc_b64 s[28:29]
L_pc1:
    s_sub_u32 s28, s28, L_pc1-sequential_preLN__ssm_conv_s4d__swiglu_ffn__prompt_kernel
    s_subb_u32 s29, s29, 0
    s_lshr_b32 s20, s2, 3
    s_lshl_b32 s20, s20, 12
    v_lshl_add_u32 v200, v0, 4, s20
    v_min_u32 v200, L_tabend-sequential_preLN__ssm_conv_s4d__swiglu_ffn__prompt_kernel-16, v200
    global_load_dwordx4 v[204:207], v200, s[28:29]
    s_load_dwordx16 s[36:51], s[0:1], 0
    s_load_dwordx8 s[52:59], s[0:1], 64
    s_load_dwordx4 s[60:63], s[0:1], 96
    v_and_b32 v1, 63, v0
    v_lshrrev_b32 v2, 6, v0
    s_nop 0
    v_readfirstlane_b32 s64, v2
    s_mov_b32 s71, 0x3f803f80
    s_cmp_lt_u32 s2, 28
    s_cbranch_scc1 L_helper
    s_sub_u32 s2, s2, 28
    s_and_b32 s65, s2, 7
    s_lshr_b32 s66, s2, 3
    s_mul_i32 s67, s66, 37
    s_lshr_b32 s67, s67, 8
    s_mul_i32 s20, s67, 7
    s_sub_u32 s68, s66, s20
    s_waitcnt lgkmcnt(0)
    s_mul_i32 s32, s65, 28
    s_add_u32 s32, s32, s66
    s_mov_b32 s4, s36
    s_and_b32 s5, s37, 0xffff
    s_mov_b32 s6, 1835008
    s_mov_b32 s7, 0x20000
    s_lshr_b32 s23, s64, 1
    s_lshl_b32 s24, s32, 1
    s_add_u32 s24, s24, s23
    s_lshl_b32 s24, s24, 9
    s_and_b32 s25, s64, 1
    s_lshl_b32 s25, s25, 8
    s_add_u32 s24, s24, s25
    v_lshl_add_u32 v84, v1, 2, s24
    s_lshl_b32 s25, s32, 2
    s_load_dword s69, s[46:47], s25
    s_load_dword s70, s[48:49], s25
    global_load_dword v66, v84, s[38:39]
    global_load_dword v67, v84, s[40:41]
    global_load_dword v68, v84, s[42:43]
    global_load_dword v69, v84, s[44:45]
    s_getpc_b64 s[26:27]
L_pc0:
    s_add_u32 s26, s26, L_idxtab-L_pc0
    s_addc_u32 s27, s27, 0
    v_lshlrev_b32 v85, 5, v0
    global_load_dwordx4 v[70:73], v85, s[26:27]
    global_load_dword v74, v85, s[26:27] offset:16
    v_mul_u32_u24 v255, 896, v1
    s_mul_i32 s50, s64, 458752
    s_lshl_b32 s21, s32, 2
    s_add_u32 s50, s50, s21
    s_lshl_b32 s51, s64, 11
    s_mov_b32 s16, s36
    s_and_b32 s17, s37, 0xffff
    s_mov_b32 s18, 1835008
    s_mov_b32 s19, 0x20000
    s_add_u32 s21, s66, 0
    s_and_b32 s21, s21, 7
    s_lshl_b32 s22, s21, 8
    s_add_u32 s22, s22, 149568
    s_add_u32 m0, s22, s51
    s_mul_i32 s21, s21, 57344
    s_add_u32 s21, s21, s50
    buffer_load_dword v255, s[16:19], s21 offen lds
    s_add_u32 s21, s66, 1
    s_and_b32 s21, s21, 7
    s_lshl_b32 s22, s21, 8
    s_add_u32 s22, s22, 149568
    s_add_u32 m0, s22, s51
    s_mul_i32 s21, s21, 57344
    s_add_u32 s21, s21, s50
    buffer_load_dword v255, s[16:19], s21 offen lds
    s_add_u32 s21, s66, 2
    s_and_b32 s21, s21, 7
    s_lshl_b32 s22, s21, 8
    s_add_u32 s22, s22, 149568
    s_add_u32 m0, s22, s51
    s_mul_i32 s21, s21, 57344
    s_add_u32 s21, s21, s50
    buffer_load_dword v255, s[16:19], s21 offen lds
    s_add_u32 s21, s66, 3
    s_and_b32 s21, s21, 7
    s_lshl_b32 s22, s21, 8
    s_add_u32 s22, s22, 149568
    s_add_u32 m0, s22, s51
    s_mul_i32 s21, s21, 57344
    s_add_u32 s21, s21, s50
    buffer_load_dword v255, s[16:19], s21 offen lds
    s_add_u32 s21, s66, 4
    s_and_b32 s21, s21, 7
    s_lshl_b32 s22, s21, 8
    s_add_u32 s22, s22, 149568
    s_add_u32 m0, s22, s51
    s_mul_i32 s21, s21, 57344
    s_add_u32 s21, s21, s50
    buffer_load_dword v255, s[16:19], s21 offen lds
    v_sub_u32 v136, 255, v0
    v_lshrrev_b32 v137, 3, v136
    v_lshl_add_u32 v137, v137, 1, v136
    v_lshlrev_b32 v137, 4, v137
    v_add_u32 v240, 32320, v137
    v_sub_u32 v136, 254, v0
    v_lshrrev_b32 v137, 3, v136
    v_lshl_add_u32 v137, v137, 1, v136
    v_lshlrev_b32 v137, 4, v137
    v_cmp_eq_u32 vcc, 255, v0
    v_mov_b32 v138, 128
    s_nop 0
    v_cndmask_b32 v137, v137, v138, vcc
    v_add_u32 v241, 32320, v137
    s_lshr_b32 s27, s65, 1
    s_lshl_b32 s27, s27, 2
    s_add_u32 s73, s27, s67
    s_and_b32 s27, s65, 1
    s_mul_i32 s27, s27, 7
    s_add_u32 s74, s27, s68
    s_lshl_b32 s75, s65, 2
    s_add_u32 s75, s75, s67
    s_mov_b32 s76, s68
    s_lshl_b32 s77, s74, 8
    s_lshl_b32 s27, s64, 6
    s_add_u32 s77, s77, s27
    s_lshr_b32 s24, s64, 1
    s_and_b32 s25, s64, 1
    v_and_b32 v141, 15, v1
    v_lshrrev_b32 v142, 4, v1
    v_and_b32 v143, 1, v141
    v_mul_u32_u24 v143, 4224, v143
    v_lshrrev_b32 v144, 1, v141
    v_add_u32 v144, v144, v142
    v_lshl_add_u32 v246, v144, 4, v143
    s_mul_i32 s26, s24, 8448
    s_lshl_b32 s27, s25, 8
    s_add_u32 s26, s26, s27
    s_add_u32 s26, s26, 0
    v_add_u32 v246, s26, v246
    v_and_b32 v143, 3, v141
    v_mul_u32_u24 v143, 6208, v143
    v_lshrrev_b32 v144, 2, v141
    v_mul_u32_u24 v145, 10, v144
    v_sub_u32 v145, 30, v145
    v_add_u32 v145, v145, v142
    v_lshl_add_u32 v247, v145, 4, v143
    s_mul_i32 s26, s24, 24832
    s_mul_i32 s27, s25, 320
    s_add_u32 s26, s26, s27
    s_add_u32 s26, s26, 32320
    v_add_u32 v247, s26, v247
    v_and_b32 v143, 3, v141
    v_lshlrev_b32 v143, 3, v143
    v_lshl_add_u32 v143, v142, 6, v143
    v_mul_u32_u24 v145, 288, v144
    v_add_u32 v143, v143, v145
    s_mul_i32 s26, s64, 9216
    s_add_u32 s26, s26, 0
    v_add_u32 v248, s26, v143
    v_lshlrev_b32 v254, 4, v0
    v_lshrrev_b32 v141, 2, v1
    v_mul_u32_u24 v249, 3584, v141
    v_and_b32 v142, 3, v1
    v_lshl_add_u32 v249, v142, 4, v249
    v_lshrrev_b32 v142, 4, v1
    v_and_b32 v143, 15, v1
    v_lshrrev_b32 v144, 1, v142
    v_lshlrev_b32 v144, 3, v144
    v_lshrrev_b32 v145, 2, v143
    v_add_u32 v144, v144, v145
    v_lshlrev_b32 v144, 6, v144
    v_and_b32 v145, 1, v142
    v_lshl_add_u32 v144, v145, 5, v144
    v_and_b32 v145, 3, v143
    v_lshl_add_u32 v253, v145, 3, v144
    s_mul_i32 s33, s64, 18432
    s_add_u32 s33, s33, 81984
    v_add_u32 v253, s33, v253
    s_mov_b32 s8, s62
    s_and_b32 s9, s63, 0xffff
    s_mov_b32 s10, 33554432
    s_mov_b32 s11, 0x20000
    s_mov_b32 s12, s52
    s_and_b32 s13, s53, 0xffff
    s_mov_b32 s14, 1605632
    s_mov_b32 s15, 0x20000
    v_lshrrev_b32 v86, 3, v0
    v_mul_u32_u24 v86, 4224, v86
    v_and_b32 v87, 7, v0
    v_lshl_add_u32 v86, v87, 4, v86
    v_mov_b32 v88, 0
    v_mov_b32 v89, 0
    v_mov_b32 v90, 0
    v_mov_b32 v91, 0
    v_lshrrev_b32 v92, 5, v0
    v_mul_u32_u24 v92, 6208, v92
    v_and_b32 v93, 31, v0
    v_lshl_add_u32 v94, v93, 4, v92
    v_and_b32 v93, 3, v93
    v_lshl_add_u32 v95, v93, 4, v92
    ds_write_b128 v94, v[88:91] offset:37376
    ds_write_b128 v95, v[88:91] offset:37888
    v_cmp_gt_u32 vcc, 32, v0
    s_nop 0
    s_and_saveexec_b64 s[28:29], vcc
    s_cbranch_execz L_nozero
    ds_write_b128 v86, v[88:91] offset:0
L_nozero:
    s_mov_b64 exec, s[28:29]
    s_waitcnt lgkmcnt(0)
    s_lshr_b32 s23, s64, 1
    s_lshl_b32 s23, s23, 4
    s_lshr_b32 s24, s69, s23
    s_lshl_b32 s24, s24, 16
    v_mov_b32 v76, 1069066811
    v_mul_f32 v76, s24, v76
    v_exp_f32 v76, v76
    s_nop 0
    v_cvt_pk_bf16_f32 v76, v76, v76
    v_lshlrev_b32 v76, 16, v76
    v_mul_f32 v77, 0xbfb8aa3b, v76
    v_mul_f32 v78, 1042479491, v76
    v_add_f32 v79, v76, v76
    s_waitcnt vmcnt(7)
    v_lshlrev_b32 v112, 16, v66
    v_lshlrev_b32 v81, 16, v67
    v_lshlrev_b32 v92, 16, v68
    v_lshlrev_b32 v93, 16, v69
    v_mul_f32 v112, 1069066811, v112
    v_exp_f32 v112, v112
    v_and_b32 v152, 0xffff0000, v66
    v_and_b32 v121, 0xffff0000, v67
    v_and_b32 v132, 0xffff0000, v68
    v_and_b32 v133, 0xffff0000, v69
    v_mul_f32 v152, 1069066811, v152
    v_exp_f32 v152, v152
    s_nop 0
    v_cvt_pk_bf16_f32 v113, v112, v152
    v_lshlrev_b32 v80, 16, v113
    v_and_b32 v120, 0xffff0000, v113
    v_mul_f32 v80, v80, v77
    v_mul_f32 v81, v81, v78
    v_mul_f32 v92, v92, v79
    v_mul_f32 v93, v93, v79
    v_mul_f32 v120, v120, v77
    v_mul_f32 v121, v121, v78
    v_mul_f32 v132, v132, v79
    v_mul_f32 v133, v133, v79
    v_exp_f32 v112, v80
    v_fract_f32 v113, v81
    v_cos_f32 v114, v113
    v_sin_f32 v115, v113
    v_exp_f32 v152, v120
    v_fract_f32 v153, v121
    v_cos_f32 v154, v153
    v_sin_f32 v155, v153
    v_mul_f32 v82, v112, v114
    v_mul_f32 v83, v112, v115
    v_mul_f32 v122, v152, v154
    v_mul_f32 v123, v152, v155
    v_mul_f32 v112, 0x43800000, v80
    v_mul_f32 v113, 0x43800000, v81
    v_exp_f32 v112, v112
    v_fract_f32 v113, v113
    v_cos_f32 v114, v113
    v_sin_f32 v115, v113
    v_mul_f32 v152, 0x43800000, v120
    v_mul_f32 v153, 0x43800000, v121
    v_exp_f32 v152, v152
    v_fract_f32 v153, v153
    v_cos_f32 v154, v153
    v_sin_f32 v155, v153
    v_mul_f32 v90, v112, v114
    v_mul_f32 v91, v112, v115
    v_mul_f32 v130, v152, v154
    v_mul_f32 v131, v152, v155
    v_pk_mul_f32 v[84:85], v[82:83], v[82:83] op_sel:[0,0] op_sel_hi:[0,1]
    v_pk_mul_f32 v[124:125], v[122:123], v[122:123] op_sel:[0,0] op_sel_hi:[0,1]
    v_pk_fma_f32 v[84:85], v[82:83], v[82:83], v[84:85] op_sel:[1,1,0] op_sel_hi:[1,0,1] neg_lo:[0,1,0]
    v_pk_fma_f32 v[124:125], v[122:123], v[122:123], v[124:125] op_sel:[1,1,0] op_sel_hi:[1,0,1] neg_lo:[0,1,0]
    v_pk_mul_f32 v[86:87], v[84:85], v[84:85] op_sel:[0,0] op_sel_hi:[0,1]
    v_pk_mul_f32 v[126:127], v[124:125], v[124:125] op_sel:[0,0] op_sel_hi:[0,1]
    v_pk_fma_f32 v[86:87], v[84:85], v[84:85], v[86:87] op_sel:[1,1,0] op_sel_hi:[1,0,1] neg_lo:[0,1,0]
    v_pk_fma_f32 v[126:127], v[124:125], v[124:125], v[126:127] op_sel:[1,1,0] op_sel_hi:[1,0,1] neg_lo:[0,1,0]
    v_pk_mul_f32 v[88:89], v[86:87], v[86:87] op_sel:[0,0] op_sel_hi:[0,1]
    v_pk_mul_f32 v[128:129], v[126:127], v[126:127] op_sel:[0,0] op_sel_hi:[0,1]
    v_pk_fma_f32 v[88:89], v[86:87], v[86:87], v[88:89] op_sel:[1,1,0] op_sel_hi:[1,0,1] neg_lo:[0,1,0]
    v_pk_fma_f32 v[128:129], v[126:127], v[126:127], v[128:129] op_sel:[1,1,0] op_sel_hi:[1,0,1] neg_lo:[0,1,0]
    s_mul_i32 s23, s64, 16896
    s_add_u32 s23, s23, 81984
    v_lshl_add_u32 v75, v1, 3, s23
    v_mov_b32 v160, 0x3f80
    v_mov_b32 v161, 0x3f80
    ds_write_b64 v75, v[160:161] offset:0
    v_pk_mul_f32 v[98:99], v[88:89], v[88:89] op_sel:[0,0] op_sel_hi:[0,1]
    v_pk_mul_f32 v[138:139], v[128:129], v[128:129] op_sel:[0,0] op_sel_hi:[0,1]
    v_pk_fma_f32 v[98:99], v[88:89], v[88:89], v[98:99] op_sel:[1,1,0] op_sel_hi:[1,0,1] neg_lo:[0,1,0]
    v_pk_fma_f32 v[138:139], v[128:129], v[128:129], v[138:139] op_sel:[1,1,0] op_sel_hi:[1,0,1] neg_lo:[0,1,0]
    v_pk_mul_f32 v[100:101], v[98:99], v[88:89] op_sel:[0,0] op_sel_hi:[0,1]
    v_pk_mul_f32 v[140:141], v[138:139], v[128:129] op_sel:[0,0] op_sel_hi:[0,1]
    v_pk_mul_f32 v[102:103], v[98:99], v[98:99] op_sel:[0,0] op_sel_hi:[0,1]
    v_pk_mul_f32 v[142:143], v[138:139], v[138:139] op_sel:[0,0] op_sel_hi:[0,1]
    v_pk_fma_f32 v[100:101], v[98:99], v[88:89], v[100:101] op_sel:[1,1,0] op_sel_hi:[1,0,1] neg_lo:[0,1,0]
    v_pk_fma_f32 v[140:141], v[138:139], v[128:129], v[140:141] op_sel:[1,1,0] op_sel_hi:[1,0,1] neg_lo:[0,1,0]
    v_pk_fma_f32 v[102:103], v[98:99], v[98:99], v[102:103] op_sel:[1,1,0] op_sel_hi:[1,0,1] neg_lo:[0,1,0]
    v_pk_fma_f32 v[142:143], v[138:139], v[138:139], v[142:143] op_sel:[1,1,0] op_sel_hi:[1,0,1] neg_lo:[0,1,0]
    v_cvt_pk_bf16_f32 v162, v88, -v89
    v_cvt_pk_bf16_f32 v163, v128, -v129
    v_cvt_pk_bf16_f32 v164, v98, -v99
    v_cvt_pk_bf16_f32 v165, v138, -v139
    v_cvt_pk_bf16_f32 v166, v100, -v101
    v_cvt_pk_bf16_f32 v167, v140, -v141
    v_cvt_pk_bf16_f32 v168, v102, -v103
    v_cvt_pk_bf16_f32 v169, v142, -v143
    ds_write_b64 v75, v[162:163] offset:528
    ds_write_b64 v75, v[164:165] offset:1056
    ds_write_b64 v75, v[166:167] offset:1584
    ds_write_b64 v75, v[168:169] offset:2112
    v_pk_mul_f32 v[106:107], v[88:89], v[102:103] op_sel:[0,0] op_sel_hi:[0,1]
    v_pk_mul_f32 v[146:147], v[128:129], v[142:143] op_sel:[0,0] op_sel_hi:[0,1]
    v_pk_mul_f32 v[108:109], v[98:99], v[102:103] op_sel:[0,0] op_sel_hi:[0,1]
    v_pk_mul_f32 v[148:149], v[138:139], v[142:143] op_sel:[0,0] op_sel_hi:[0,1]
    v_pk_mul_f32 v[110:111], v[100:101], v[102:103] op_sel:[0,0] op_sel_hi:[0,1]
    v_pk_mul_f32 v[150:151], v[140:141], v[142:143] op_sel:[0,0] op_sel_hi:[0,1]
    v_pk_fma_f32 v[106:107], v[88:89], v[102:103], v[106:107] op_sel:[1,1,0] op_sel_hi:[1,0,1] neg_lo:[0,1,0]
    v_pk_fma_f32 v[146:147], v[128:129], v[142:143], v[146:147] op_sel:[1,1,0] op_sel_hi:[1,0,1] neg_lo:[0,1,0]
    v_pk_fma_f32 v[108:109], v[98:99], v[102:103], v[108:109] op_sel:[1,1,0] op_sel_hi:[1,0,1] neg_lo:[0,1,0]
    v_pk_fma_f32 v[148:149], v[138:139], v[142:143], v[148:149] op_sel:[1,1,0] op_sel_hi:[1,0,1] neg_lo:[0,1,0]
    v_pk_fma_f32 v[110:111], v[100:101], v[102:103], v[110:111] op_sel:[1,1,0] op_sel_hi:[1,0,1] neg_lo:[0,1,0]
    v_pk_fma_f32 v[150:151], v[140:141], v[142:143], v[150:151] op_sel:[1,1,0] op_sel_hi:[1,0,1] neg_lo:[0,1,0]
    v_cvt_pk_bf16_f32 v170, v106, -v107
    v_cvt_pk_bf16_f32 v171, v146, -v147
    v_cvt_pk_bf16_f32 v172, v108, -v109
    v_cvt_pk_bf16_f32 v173, v148, -v149
    v_cvt_pk_bf16_f32 v174, v110, -v111
    v_cvt_pk_bf16_f32 v175, v150, -v151
    ds_write_b64 v75, v[170:171] offset:2640
    ds_write_b64 v75, v[172:173] offset:3168
    ds_write_b64 v75, v[174:175] offset:3696
    v_pk_mul_f32 v[94:95], v[102:103], v[102:103] op_sel:[0,0] op_sel_hi:[0,1]
    v_pk_mul_f32 v[134:135], v[142:143], v[142:143] op_sel:[0,0] op_sel_hi:[0,1]
    v_pk_mul_f32 v[96:97], v[106:107], v[102:103] op_sel:[0,0] op_sel_hi:[0,1]
    v_pk_mul_f32 v[136:137], v[146:147], v[142:143] op_sel:[0,0] op_sel_hi:[0,1]
    v_pk_mul_f32 v[98:99], v[108:109], v[102:103] op_sel:[0,0] op_sel_hi:[0,1]
    v_pk_mul_f32 v[138:139], v[148:149], v[142:143] op_sel:[0,0] op_sel_hi:[0,1]
    v_pk_mul_f32 v[100:101], v[110:111], v[102:103] op_sel:[0,0] op_sel_hi:[0,1]
    v_pk_mul_f32 v[140:141], v[150:151], v[142:143] op_sel:[0,0] op_sel_hi:[0,1]
    v_pk_fma_f32 v[94:95], v[102:103], v[102:103], v[94:95] op_sel:[1,1,0] op_sel_hi:[1,0,1] neg_lo:[0,1,0]
    v_pk_fma_f32 v[134:135], v[142:143], v[142:143], v[134:135] op_sel:[1,1,0] op_sel_hi:[1,0,1] neg_lo:[0,1,0]
    v_pk_fma_f32 v[96:97], v[106:107], v[102:103], v[96:97] op_sel:[1,1,0] op_sel_hi:[1,0,1] neg_lo:[0,1,0]
    v_pk_fma_f32 v[136:137], v[146:147], v[142:143], v[136:137] op_sel:[1,1,0] op_sel_hi:[1,0,1] neg_lo:[0,1,0]
    v_pk_fma_f32 v[98:99], v[108:109], v[102:103], v[98:99] op_sel:[1,1,0] op_sel_hi:[1,0,1] neg_lo:[0,1,0]
    v_pk_fma_f32 v[138:139], v[148:149], v[142:143], v[138:139] op_sel:[1,1,0] op_sel_hi:[1,0,1] neg_lo:[0,1,0]
    v_pk_fma_f32 v[100:101], v[110:111], v[102:103], v[100:101] op_sel:[1,1,0] op_sel_hi:[1,0,1] neg_lo:[0,1,0]
    v_pk_fma_f32 v[140:141], v[150:151], v[142:143], v[140:141] op_sel:[1,1,0] op_sel_hi:[1,0,1] neg_lo:[0,1,0]
    v_cvt_pk_bf16_f32 v160, v94, -v95
    v_cvt_pk_bf16_f32 v161, v134, -v135
    v_cvt_pk_bf16_f32 v162, v96, -v97
    v_cvt_pk_bf16_f32 v163, v136, -v137
    v_cvt_pk_bf16_f32 v164, v98, -v99
    v_cvt_pk_bf16_f32 v165, v138, -v139
    v_cvt_pk_bf16_f32 v166, v100, -v101
    v_cvt_pk_bf16_f32 v167, v140, -v141
    ds_write_b64 v75, v[160:161] offset:4224
    ds_write_b64 v75, v[162:163] offset:4752
    ds_write_b64 v75, v[164:165] offset:5280
    ds_write_b64 v75, v[166:167] offset:5808
    v_pk_mul_f32 v[104:105], v[94:95], v[102:103] op_sel:[0,0] op_sel_hi:[0,1]
    v_pk_mul_f32 v[144:145], v[134:135], v[142:143] op_sel:[0,0] op_sel_hi:[0,1]
    v_pk_mul_f32 v[106:107], v[96:97], v[102:103] op_sel:[0,0] op_sel_hi:[0,1]
    v_pk_mul_f32 v[146:147], v[136:137], v[142:143] op_sel:[0,0] op_sel_hi:[0,1]
    v_pk_mul_f32 v[108:109], v[98:99], v[102:103] op_sel:[0,0] op_sel_hi:[0,1]
    v_pk_mul_f32 v[148:149], v[138:139], v[142:143] op_sel:[0,0] op_sel_hi:[0,1]
    v_pk_mul_f32 v[110:111], v[100:101], v[102:103] op_sel:[0,0] op_sel_hi:[0,1]
    v_pk_mul_f32 v[150:151], v[140:141], v[142:143] op_sel:[0,0] op_sel_hi:[0,1]
    v_pk_fma_f32 v[104:105], v[94:95], v[102:103], v[104:105] op_sel:[1,1,0] op_sel_hi:[1,0,1] neg_lo:[0,1,0]
    v_pk_fma_f32 v[144:145], v[134:135], v[142:143], v[144:145] op_sel:[1,1,0] op_sel_hi:[1,0,1] neg_lo:[0,1,0]
    v_pk_fma_f32 v[106:107], v[96:97], v[102:103], v[106:107] op_sel:[1,1,0] op_sel_hi:[1,0,1] neg_lo:[0,1,0]
    v_pk_fma_f32 v[146:147], v[136:137], v[142:143], v[146:147] op_sel:[1,1,0] op_sel_hi:[1,0,1] neg_lo:[0,1,0]
    v_pk_fma_f32 v[108:109], v[98:99], v[102:103], v[108:109] op_sel:[1,1,0] op_sel_hi:[1,0,1] neg_lo:[0,1,0]
    v_pk_fma_f32 v[148:149], v[138:139], v[142:143], v[148:149] op_sel:[1,1,0] op_sel_hi:[1,0,1] neg_lo:[0,1,0]
    v_pk_fma_f32 v[110:111], v[100:101], v[102:103], v[110:111] op_sel:[1,1,0] op_sel_hi:[1,0,1] neg_lo:[0,1,0]
    v_pk_fma_f32 v[150:151], v[140:141], v[142:143], v[150:151] op_sel:[1,1,0] op_sel_hi:[1,0,1] neg_lo:[0,1,0]
    v_cvt_pk_bf16_f32 v168, v104, -v105
    v_cvt_pk_bf16_f32 v169, v144, -v145
    v_cvt_pk_bf16_f32 v170, v106, -v107
    v_cvt_pk_bf16_f32 v171, v146, -v147
    v_cvt_pk_bf16_f32 v172, v108, -v109
    v_cvt_pk_bf16_f32 v173, v148, -v149
    v_cvt_pk_bf16_f32 v174, v110, -v111
    v_cvt_pk_bf16_f32 v175, v150, -v151
    ds_write_b64 v75, v[168:169] offset:6336
    ds_write_b64 v75, v[170:171] offset:6864
    ds_write_b64 v75, v[172:173] offset:7392
    ds_write_b64 v75, v[174:175] offset:7920
    v_pk_mul_f32 v[94:95], v[104:105], v[102:103] op_sel:[0,0] op_sel_hi:[0,1]
    v_pk_mul_f32 v[134:135], v[144:145], v[142:143] op_sel:[0,0] op_sel_hi:[0,1]
    v_pk_mul_f32 v[96:97], v[106:107], v[102:103] op_sel:[0,0] op_sel_hi:[0,1]
    v_pk_mul_f32 v[136:137], v[146:147], v[142:143] op_sel:[0,0] op_sel_hi:[0,1]
    v_pk_mul_f32 v[98:99], v[108:109], v[102:103] op_sel:[0,0] op_sel_hi:[0,1]
    v_pk_mul_f32 v[138:139], v[148:149], v[142:143] op_sel:[0,0] op_sel_hi:[0,1]
    v_pk_mul_f32 v[100:101], v[110:111], v[102:103] op_sel:[0,0] op_sel_hi:[0,1]
    v_pk_mul_f32 v[140:141], v[150:151], v[142:143] op_sel:[0,0] op_sel_hi:[0,1]
    v_pk_fma_f32 v[94:95], v[104:105], v[102:103], v[94:95] op_sel:[1,1,0] op_sel_hi:[1,0,1] neg_lo:[0,1,0]
    v_pk_fma_f32 v[134:135], v[144:145], v[142:143], v[134:135] op_sel:[1,1,0] op_sel_hi:[1,0,1] neg_lo:[0,1,0]
    v_pk_fma_f32 v[96:97], v[106:107], v[102:103], v[96:97] op_sel:[1,1,0] op_sel_hi:[1,0,1] neg_lo:[0,1,0]
    v_pk_fma_f32 v[136:137], v[146:147], v[142:143], v[136:137] op_sel:[1,1,0] op_sel_hi:[1,0,1] neg_lo:[0,1,0]
    v_pk_fma_f32 v[98:99], v[108:109], v[102:103], v[98:99] op_sel:[1,1,0] op_sel_hi:[1,0,1] neg_lo:[0,1,0]
    v_pk_fma_f32 v[138:139], v[148:149], v[142:143], v[138:139] op_sel:[1,1,0] op_sel_hi:[1,0,1] neg_lo:[0,1,0]
    v_pk_fma_f32 v[100:101], v[110:111], v[102:103], v[100:101] op_sel:[1,1,0] op_sel_hi:[1,0,1] neg_lo:[0,1,0]
    v_pk_fma_f32 v[140:141], v[150:151], v[142:143], v[140:141] op_sel:[1,1,0] op_sel_hi:[1,0,1] neg_lo:[0,1,0]
    v_cvt_pk_bf16_f32 v160, v94, -v95
    v_cvt_pk_bf16_f32 v161, v134, -v135
    v_cvt_pk_bf16_f32 v162, v96, -v97
    v_cvt_pk_bf16_f32 v163, v136, -v137
    v_cvt_pk_bf16_f32 v164, v98, -v99
    v_cvt_pk_bf16_f32 v165, v138, -v139
    v_cvt_pk_bf16_f32 v166, v100, -v101
    v_cvt_pk_bf16_f32 v167, v140, -v141
    ds_write_b64 v75, v[160:161] offset:8448
    ds_write_b64 v75, v[162:163] offset:8976
    ds_write_b64 v75, v[164:165] offset:9504
    ds_write_b64 v75, v[166:167] offset:10032
    v_pk_mul_f32 v[104:105], v[94:95], v[102:103] op_sel:[0,0] op_sel_hi:[0,1]
    v_pk_mul_f32 v[144:145], v[134:135], v[142:143] op_sel:[0,0] op_sel_hi:[0,1]
    v_pk_mul_f32 v[106:107], v[96:97], v[102:103] op_sel:[0,0] op_sel_hi:[0,1]
    v_pk_mul_f32 v[146:147], v[136:137], v[142:143] op_sel:[0,0] op_sel_hi:[0,1]
    v_pk_mul_f32 v[108:109], v[98:99], v[102:103] op_sel:[0,0] op_sel_hi:[0,1]
    v_pk_mul_f32 v[148:149], v[138:139], v[142:143] op_sel:[0,0] op_sel_hi:[0,1]
    v_pk_mul_f32 v[110:111], v[100:101], v[102:103] op_sel:[0,0] op_sel_hi:[0,1]
    v_pk_mul_f32 v[150:151], v[140:141], v[142:143] op_sel:[0,0] op_sel_hi:[0,1]
    v_pk_fma_f32 v[104:105], v[94:95], v[102:103], v[104:105] op_sel:[1,1,0] op_sel_hi:[1,0,1] neg_lo:[0,1,0]
    v_pk_fma_f32 v[144:145], v[134:135], v[142:143], v[144:145] op_sel:[1,1,0] op_sel_hi:[1,0,1] neg_lo:[0,1,0]
    v_pk_fma_f32 v[106:107], v[96:97], v[102:103], v[106:107] op_sel:[1,1,0] op_sel_hi:[1,0,1] neg_lo:[0,1,0]
    v_pk_fma_f32 v[146:147], v[136:137], v[142:143], v[146:147] op_sel:[1,1,0] op_sel_hi:[1,0,1] neg_lo:[0,1,0]
    v_pk_fma_f32 v[108:109], v[98:99], v[102:103], v[108:109] op_sel:[1,1,0] op_sel_hi:[1,0,1] neg_lo:[0,1,0]
    v_pk_fma_f32 v[148:149], v[138:139], v[142:143], v[148:149] op_sel:[1,1,0] op_sel_hi:[1,0,1] neg_lo:[0,1,0]
    v_pk_fma_f32 v[110:111], v[100:101], v[102:103], v[110:111] op_sel:[1,1,0] op_sel_hi:[1,0,1] neg_lo:[0,1,0]
    v_pk_fma_f32 v[150:151], v[140:141], v[142:143], v[150:151] op_sel:[1,1,0] op_sel_hi:[1,0,1] neg_lo:[0,1,0]
    v_cvt_pk_bf16_f32 v168, v104, -v105
    v_cvt_pk_bf16_f32 v169, v144, -v145
    v_cvt_pk_bf16_f32 v170, v106, -v107
    v_cvt_pk_bf16_f32 v171, v146, -v147
    v_cvt_pk_bf16_f32 v172, v108, -v109
    v_cvt_pk_bf16_f32 v173, v148, -v149
    v_cvt_pk_bf16_f32 v174, v110, -v111
    v_cvt_pk_bf16_f32 v175, v150, -v151
    ds_write_b64 v75, v[168:169] offset:10560
    ds_write_b64 v75, v[170:171] offset:11088
    ds_write_b64 v75, v[172:173] offset:11616
    ds_write_b64 v75, v[174:175] offset:12144
    v_pk_mul_f32 v[94:95], v[104:105], v[102:103] op_sel:[0,0] op_sel_hi:[0,1]
    v_pk_mul_f32 v[134:135], v[144:145], v[142:143] op_sel:[0,0] op_sel_hi:[0,1]
    v_pk_mul_f32 v[96:97], v[106:107], v[102:103] op_sel:[0,0] op_sel_hi:[0,1]
    v_pk_mul_f32 v[136:137], v[146:147], v[142:143] op_sel:[0,0] op_sel_hi:[0,1]
    v_pk_mul_f32 v[98:99], v[108:109], v[102:103] op_sel:[0,0] op_sel_hi:[0,1]
    v_pk_mul_f32 v[138:139], v[148:149], v[142:143] op_sel:[0,0] op_sel_hi:[0,1]
    v_pk_mul_f32 v[100:101], v[110:111], v[102:103] op_sel:[0,0] op_sel_hi:[0,1]
    v_pk_mul_f32 v[140:141], v[150:151], v[142:143] op_sel:[0,0] op_sel_hi:[0,1]
    v_pk_fma_f32 v[94:95], v[104:105], v[102:103], v[94:95] op_sel:[1,1,0] op_sel_hi:[1,0,1] neg_lo:[0,1,0]
    v_pk_fma_f32 v[134:135], v[144:145], v[142:143], v[134:135] op_sel:[1,1,0] op_sel_hi:[1,0,1] neg_lo:[0,1,0]
    v_pk_fma_f32 v[96:97], v[106:107], v[102:103], v[96:97] op_sel:[1,1,0] op_sel_hi:[1,0,1] neg_lo:[0,1,0]
    v_pk_fma_f32 v[136:137], v[146:147], v[142:143], v[136:137] op_sel:[1,1,0] op_sel_hi:[1,0,1] neg_lo:[0,1,0]
    v_pk_fma_f32 v[98:99], v[108:109], v[102:103], v[98:99] op_sel:[1,1,0] op_sel_hi:[1,0,1] neg_lo:[0,1,0]
    v_pk_fma_f32 v[138:139], v[148:149], v[142:143], v[138:139] op_sel:[1,1,0] op_sel_hi:[1,0,1] neg_lo:[0,1,0]
    v_pk_fma_f32 v[100:101], v[110:111], v[102:103], v[100:101] op_sel:[1,1,0] op_sel_hi:[1,0,1] neg_lo:[0,1,0]
    v_pk_fma_f32 v[140:141], v[150:151], v[142:143], v[140:141] op_sel:[1,1,0] op_sel_hi:[1,0,1] neg_lo:[0,1,0]
    v_cvt_pk_bf16_f32 v160, v94, -v95
    v_cvt_pk_bf16_f32 v161, v134, -v135
    v_cvt_pk_bf16_f32 v162, v96, -v97
    v_cvt_pk_bf16_f32 v163, v136, -v137
    v_cvt_pk_bf16_f32 v164, v98, -v99
    v_cvt_pk_bf16_f32 v165, v138, -v139
    v_cvt_pk_bf16_f32 v166, v100, -v101
    v_cvt_pk_bf16_f32 v167, v140, -v141
    ds_write_b64 v75, v[160:161] offset:12672
    ds_write_b64 v75, v[162:163] offset:13200
    ds_write_b64 v75, v[164:165] offset:13728
    ds_write_b64 v75, v[166:167] offset:14256
    v_pk_mul_f32 v[104:105], v[94:95], v[102:103] op_sel:[0,0] op_sel_hi:[0,1]
    v_pk_mul_f32 v[144:145], v[134:135], v[142:143] op_sel:[0,0] op_sel_hi:[0,1]
    v_pk_mul_f32 v[106:107], v[96:97], v[102:103] op_sel:[0,0] op_sel_hi:[0,1]
    v_pk_mul_f32 v[146:147], v[136:137], v[142:143] op_sel:[0,0] op_sel_hi:[0,1]
    v_pk_mul_f32 v[108:109], v[98:99], v[102:103] op_sel:[0,0] op_sel_hi:[0,1]
    v_pk_mul_f32 v[148:149], v[138:139], v[142:143] op_sel:[0,0] op_sel_hi:[0,1]
    v_pk_mul_f32 v[110:111], v[100:101], v[102:103] op_sel:[0,0] op_sel_hi:[0,1]
    v_pk_mul_f32 v[150:151], v[140:141], v[142:143] op_sel:[0,0] op_sel_hi:[0,1]
    v_pk_fma_f32 v[104:105], v[94:95], v[102:103], v[104:105] op_sel:[1,1,0] op_sel_hi:[1,0,1] neg_lo:[0,1,0]
    v_pk_fma_f32 v[144:145], v[134:135], v[142:143], v[144:145] op_sel:[1,1,0] op_sel_hi:[1,0,1] neg_lo:[0,1,0]
    v_pk_fma_f32 v[106:107], v[96:97], v[102:103], v[106:107] op_sel:[1,1,0] op_sel_hi:[1,0,1] neg_lo:[0,1,0]
    v_pk_fma_f32 v[146:147], v[136:137], v[142:143], v[146:147] op_sel:[1,1,0] op_sel_hi:[1,0,1] neg_lo:[0,1,0]
    v_pk_fma_f32 v[108:109], v[98:99], v[102:103], v[108:109] op_sel:[1,1,0] op_sel_hi:[1,0,1] neg_lo:[0,1,0]
    v_pk_fma_f32 v[148:149], v[138:139], v[142:143], v[148:149] op_sel:[1,1,0] op_sel_hi:[1,0,1] neg_lo:[0,1,0]
    v_pk_fma_f32 v[110:111], v[100:101], v[102:103], v[110:111] op_sel:[1,1,0] op_sel_hi:[1,0,1] neg_lo:[0,1,0]
    v_pk_fma_f32 v[150:151], v[140:141], v[142:143], v[150:151] op_sel:[1,1,0] op_sel_hi:[1,0,1] neg_lo:[0,1,0]
    v_cvt_pk_bf16_f32 v168, v104, -v105
    v_cvt_pk_bf16_f32 v169, v144, -v145
    v_cvt_pk_bf16_f32 v170, v106, -v107
    v_cvt_pk_bf16_f32 v171, v146, -v147
    v_cvt_pk_bf16_f32 v172, v108, -v109
    v_cvt_pk_bf16_f32 v173, v148, -v149
    v_cvt_pk_bf16_f32 v174, v110, -v111
    v_cvt_pk_bf16_f32 v175, v150, -v151
    ds_write_b64 v75, v[168:169] offset:14784
    ds_write_b64 v75, v[170:171] offset:15312
    ds_write_b64 v75, v[172:173] offset:15840
    ds_write_b64 v75, v[174:175] offset:16368
    s_cmp_eq_u32 s64, 2
    s_cselect_b32 s4, s54, s52
    s_cselect_b32 s5, s55, s53
    s_and_b32 s5, s5, 0xffff
    s_mov_b32 s6, 1605632
    s_mov_b32 s7, 0x20000
    s_lshl_b32 s24, s66, 4
    s_mul_i32 s24, s24, 3584
    s_and_b32 s25, s65, 1
    s_mul_i32 s25, s25, 1792
    s_add_u32 s24, s24, s25
    s_sub_u32 s25, s64, 1
    s_cmp_lt_u32 s25, 2
    s_cselect_b32 s24, s24, 0x40000000
    v_min_u32 v252, 55, v1
    v_mul_u32_u24 v251, 4682, v252
    v_lshrrev_b32 v251, 16, v251
    v_mul_u32_u24 v250, 14, v251
    v_sub_u32 v252, v252, v250
    v_lshlrev_b32 v252, 7, v252
    v_mul_u32_u24 v251, 3584, v251
    v_add_u32 v252, v252, v251
    s_add_u32 s25, s24, 0
    buffer_load_dword v251, v252, s[4:7], s25 offen
    s_add_u32 s25, s24, 14336
    buffer_load_dword v251, v252, s[4:7], s25 offen
    s_add_u32 s25, s24, 28672
    buffer_load_dword v251, v252, s[4:7], s25 offen
    s_add_u32 s25, s24, 43008
    buffer_load_dword v251, v252, s[4:7], s25 offen
    v_and_b32 v156, 31, v1
    v_mul_u32_u24 v156, 528, v156
    v_lshrrev_b32 v157, 5, v1
    v_lshl_add_u32 v156, v157, 4, v156
    v_add_u32 v156, s23, v156
    s_add_u32 s21, s66, 5
    s_and_b32 s21, s21, 7
    s_lshl_b32 s22, s21, 8
    s_add_u32 s22, s22, 149568
    s_add_u32 m0, s22, s51
    s_mul_i32 s21, s21, 57344
    s_add_u32 s21, s21, s50
    buffer_load_dword v255, s[16:19], s21 offen lds
    s_waitcnt lgkmcnt(0)
    ds_read_b128 v[176:179], v156 offset:0
    ds_read_b128 v[180:183], v156 offset:32
    ds_read_b128 v[184:187], v156 offset:64
    ds_read_b128 v[188:191], v156 offset:96
    ds_read_b128 v[192:195], v156 offset:128
    ds_read_b128 v[196:199], v156 offset:160
    ds_read_b128 v[200:203], v156 offset:192
    ds_read_b128 v[204:207], v156 offset:224
    ds_read_b128 v[208:211], v156 offset:256
    ds_read_b128 v[212:215], v156 offset:288
    ds_read_b128 v[216:219], v156 offset:320
    ds_read_b128 v[220:223], v156 offset:352
    s_waitcnt lgkmcnt(8)
    ds_read_b128 v[224:227], v156 offset:384
    ds_read_b128 v[228:231], v156 offset:416
    ds_read_b128 v[232:235], v156 offset:448
    ds_read_b128 v[236:239], v156 offset:480
    s_add_u32 s21, s66, 6
    s_and_b32 s21, s21, 7
    s_lshl_b32 s22, s21, 8
    s_add_u32 s22, s22, 149568
    s_add_u32 m0, s22, s51
    s_mul_i32 s21, s21, 57344
    s_add_u32 s21, s21, s50
    buffer_load_dword v255, s[16:19], s21 offen lds
    v_pk_mul_f32 v[94:95], v[92:93], v[82:83] op_sel:[0,0] op_sel_hi:[0,1]
    v_pk_mul_f32 v[134:135], v[132:133], v[122:123] op_sel:[0,0] op_sel_hi:[0,1]
    v_pk_mul_f32 v[96:97], v[92:93], v[84:85] op_sel:[0,0] op_sel_hi:[0,1]
    v_pk_mul_f32 v[136:137], v[132:133], v[124:125] op_sel:[0,0] op_sel_hi:[0,1]
    v_pk_mul_f32 v[98:99], v[92:93], v[86:87] op_sel:[0,0] op_sel_hi:[0,1]
    v_pk_mul_f32 v[138:139], v[132:133], v[126:127] op_sel:[0,0] op_sel_hi:[0,1]
    v_pk_mul_f32 v[100:101], v[92:93], v[90:91] op_sel:[0,0] op_sel_hi:[0,1]
    v_pk_mul_f32 v[140:141], v[132:133], v[130:131] op_sel:[0,0] op_sel_hi:[0,1]
    v_pk_mul_f32 v[104:105], v[90:91], v[90:91] op_sel:[0,0] op_sel_hi:[0,1]
    v_pk_mul_f32 v[144:145], v[130:131], v[130:131] op_sel:[0,0] op_sel_hi:[0,1]
    v_pk_fma_f32 v[94:95], v[92:93], v[82:83], v[94:95] op_sel:[1,1,0] op_sel_hi:[1,0,1] neg_lo:[0,1,0]
    v_pk_fma_f32 v[134:135], v[132:133], v[122:123], v[134:135] op_sel:[1,1,0] op_sel_hi:[1,0,1] neg_lo:[0,1,0]
    v_pk_fma_f32 v[96:97], v[92:93], v[84:85], v[96:97] op_sel:[1,1,0] op_sel_hi:[1,0,1] neg_lo:[0,1,0]
    v_pk_fma_f32 v[136:137], v[132:133], v[124:125], v[136:137] op_sel:[1,1,0] op_sel_hi:[1,0,1] neg_lo:[0,1,0]
    v_pk_fma_f32 v[98:99], v[92:93], v[86:87], v[98:99] op_sel:[1,1,0] op_sel_hi:[1,0,1] neg_lo:[0,1,0]
    v_pk_fma_f32 v[138:139], v[132:133], v[126:127], v[138:139] op_sel:[1,1,0] op_sel_hi:[1,0,1] neg_lo:[0,1,0]
    v_pk_fma_f32 v[100:101], v[92:93], v[90:91], v[100:101] op_sel:[1,1,0] op_sel_hi:[1,0,1] neg_lo:[0,1,0]
    v_pk_fma_f32 v[140:141], v[132:133], v[130:131], v[140:141] op_sel:[1,1,0] op_sel_hi:[1,0,1] neg_lo:[0,1,0]
    v_pk_fma_f32 v[104:105], v[90:91], v[90:91], v[104:105] op_sel:[1,1,0] op_sel_hi:[1,0,1] neg_lo:[0,1,0]
    v_pk_fma_f32 v[144:145], v[130:131], v[130:131], v[144:145] op_sel:[1,1,0] op_sel_hi:[1,0,1] neg_lo:[0,1,0]
    v_pk_mul_f32 v[106:107], v[94:95], v[84:85] op_sel:[0,0] op_sel_hi:[0,1]
    v_pk_mul_f32 v[146:147], v[134:135], v[124:125] op_sel:[0,0] op_sel_hi:[0,1]
    v_pk_mul_f32 v[108:109], v[94:95], v[86:87] op_sel:[0,0] op_sel_hi:[0,1]
    v_pk_mul_f32 v[148:149], v[134:135], v[126:127] op_sel:[0,0] op_sel_hi:[0,1]
    v_pk_mul_f32 v[110:111], v[96:97], v[86:87] op_sel:[0,0] op_sel_hi:[0,1]
    v_pk_mul_f32 v[150:151], v[136:137], v[126:127] op_sel:[0,0] op_sel_hi:[0,1]
    v_pk_mul_f32 v[2:3], v[100:101], v[84:85] op_sel:[0,0] op_sel_hi:[0,1]
    v_pk_mul_f32 v[34:35], v[140:141], v[124:125] op_sel:[0,0] op_sel_hi:[0,1]
    v_pk_mul_f32 v[4:5], v[100:101], v[86:87] op_sel:[0,0] op_sel_hi:[0,1]
    v_pk_mul_f32 v[36:37], v[140:141], v[126:127] op_sel:[0,0] op_sel_hi:[0,1]
    v_pk_mul_f32 v[6:7], v[92:93], v[104:105] op_sel:[0,0] op_sel_hi:[0,1]
    v_pk_mul_f32 v[38:39], v[132:133], v[144:145] op_sel:[0,0] op_sel_hi:[0,1]
    v_pk_mul_f32 v[8:9], v[100:101], v[104:105] op_sel:[0,0] op_sel_hi:[0,1]
    v_pk_mul_f32 v[40:41], v[140:141], v[144:145] op_sel:[0,0] op_sel_hi:[0,1]
    v_pk_mul_f32 v[10:11], v[104:105], v[104:105] op_sel:[0,0] op_sel_hi:[0,1]
    v_pk_mul_f32 v[42:43], v[144:145], v[144:145] op_sel:[0,0] op_sel_hi:[0,1]
    v_pk_fma_f32 v[106:107], v[94:95], v[84:85], v[106:107] op_sel:[1,1,0] op_sel_hi:[1,0,1] neg_lo:[0,1,0]
    v_pk_fma_f32 v[146:147], v[134:135], v[124:125], v[146:147] op_sel:[1,1,0] op_sel_hi:[1,0,1] neg_lo:[0,1,0]
    v_pk_fma_f32 v[108:109], v[94:95], v[86:87], v[108:109] op_sel:[1,1,0] op_sel_hi:[1,0,1] neg_lo:[0,1,0]
    v_pk_fma_f32 v[148:149], v[134:135], v[126:127], v[148:149] op_sel:[1,1,0] op_sel_hi:[1,0,1] neg_lo:[0,1,0]
    v_pk_fma_f32 v[110:111], v[96:97], v[86:87], v[110:111] op_sel:[1,1,0] op_sel_hi:[1,0,1] neg_lo:[0,1,0]
    v_pk_fma_f32 v[150:151], v[136:137], v[126:127], v[150:151] op_sel:[1,1,0] op_sel_hi:[1,0,1] neg_lo:[0,1,0]
    v_pk_fma_f32 v[2:3], v[100:101], v[84:85], v[2:3] op_sel:[1,1,0] op_sel_hi:[1,0,1] neg_lo:[0,1,0]
    v_pk_fma_f32 v[34:35], v[140:141], v[124:125], v[34:35] op_sel:[1,1,0] op_sel_hi:[1,0,1] neg_lo:[0,1,0]
    v_pk_fma_f32 v[4:5], v[100:101], v[86:87], v[4:5] op_sel:[1,1,0] op_sel_hi:[1,0,1] neg_lo:[0,1,0]
    v_pk_fma_f32 v[36:37], v[140:141], v[126:127], v[36:37] op_sel:[1,1,0] op_sel_hi:[1,0,1] neg_lo:[0,1,0]
    v_pk_fma_f32 v[6:7], v[92:93], v[104:105], v[6:7] op_sel:[1,1,0] op_sel_hi:[1,0,1] neg_lo:[0,1,0]
    v_pk_fma_f32 v[38:39], v[132:133], v[144:145], v[38:39] op_sel:[1,1,0] op_sel_hi:[1,0,1] neg_lo:[0,1,0]
    v_pk_fma_f32 v[8:9], v[100:101], v[104:105], v[8:9] op_sel:[1,1,0] op_sel_hi:[1,0,1] neg_lo:[0,1,0]
    v_pk_fma_f32 v[40:41], v[140:141], v[144:145], v[40:41] op_sel:[1,1,0] op_sel_hi:[1,0,1] neg_lo:[0,1,0]
    v_pk_fma_f32 v[10:11], v[104:105], v[104:105], v[10:11] op_sel:[1,1,0] op_sel_hi:[1,0,1] neg_lo:[0,1,0]
    v_pk_fma_f32 v[42:43], v[144:145], v[144:145], v[42:43] op_sel:[1,1,0] op_sel_hi:[1,0,1] neg_lo:[0,1,0]
    s_waitcnt lgkmcnt(0)
    v_cvt_pk_bf16_f32 v160, v92, v93
    v_cvt_pk_bf16_f32 v161, v132, v133
    v_cvt_pk_bf16_f32 v162, v94, v95
    v_cvt_pk_bf16_f32 v163, v134, v135
    v_cvt_pk_bf16_f32 v164, v96, v97
    v_cvt_pk_bf16_f32 v165, v136, v137
    v_cvt_pk_bf16_f32 v166, v106, v107
    v_cvt_pk_bf16_f32 v167, v146, v147
    ds_write_b64 v75, v[160:161] offset:0
    ds_write_b64 v75, v[162:163] offset:528
    ds_write_b64 v75, v[164:165] offset:1056
    ds_write_b64 v75, v[166:167] offset:1584
    v_cvt_pk_bf16_f32 v168, v98, v99
    v_cvt_pk_bf16_f32 v169, v138, v139
    v_cvt_pk_bf16_f32 v170, v108, v109
    v_cvt_pk_bf16_f32 v171, v148, v149
    v_cvt_pk_bf16_f32 v172, v110, v111
    v_cvt_pk_bf16_f32 v173, v150, v151
    v_cvt_pk_bf16_f32 v174, v100, v101
    v_cvt_pk_bf16_f32 v175, v140, v141
    ds_write_b64 v75, v[168:169] offset:2112
    ds_write_b64 v75, v[170:171] offset:2640
    ds_write_b64 v75, v[172:173] offset:3168
    ds_write_b64 v75, v[174:175] offset:4224
    v_cvt_pk_bf16_f32 v160, v2, v3
    v_cvt_pk_bf16_f32 v161, v34, v35
    v_cvt_pk_bf16_f32 v162, v4, v5
    v_cvt_pk_bf16_f32 v163, v36, v37
    v_cvt_pk_bf16_f32 v164, v6, v7
    v_cvt_pk_bf16_f32 v165, v38, v39
    v_cvt_pk_bf16_f32 v166, v8, v9
    v_cvt_pk_bf16_f32 v167, v40, v41
    ds_write_b64 v75, v[160:161] offset:4752
    ds_write_b64 v75, v[162:163] offset:5280
    ds_write_b64 v75, v[164:165] offset:6336
    ds_write_b64 v75, v[166:167] offset:7392
    v_pk_mul_f32 v[12:13], v[106:107], v[86:87] op_sel:[0,0] op_sel_hi:[0,1]
    v_pk_mul_f32 v[44:45], v[146:147], v[126:127] op_sel:[0,0] op_sel_hi:[0,1]
    v_pk_mul_f32 v[14:15], v[2:3], v[86:87] op_sel:[0,0] op_sel_hi:[0,1]
    v_pk_mul_f32 v[46:47], v[34:35], v[126:127] op_sel:[0,0] op_sel_hi:[0,1]
    v_pk_mul_f32 v[16:17], v[6:7], v[86:87] op_sel:[0,0] op_sel_hi:[0,1]
    v_pk_mul_f32 v[48:49], v[38:39], v[126:127] op_sel:[0,0] op_sel_hi:[0,1]
    v_pk_mul_f32 v[18:19], v[8:9], v[86:87] op_sel:[0,0] op_sel_hi:[0,1]
    v_pk_mul_f32 v[50:51], v[40:41], v[126:127] op_sel:[0,0] op_sel_hi:[0,1]
    v_pk_mul_f32 v[20:21], v[92:93], v[10:11] op_sel:[0,0] op_sel_hi:[0,1]
    v_pk_mul_f32 v[52:53], v[132:133], v[42:43] op_sel:[0,0] op_sel_hi:[0,1]
    v_pk_mul_f32 v[22:23], v[100:101], v[10:11] op_sel:[0,0] op_sel_hi:[0,1]
    v_pk_mul_f32 v[54:55], v[140:141], v[42:43] op_sel:[0,0] op_sel_hi:[0,1]
    v_pk_mul_f32 v[24:25], v[6:7], v[10:11] op_sel:[0,0] op_sel_hi:[0,1]
    v_pk_mul_f32 v[56:57], v[38:39], v[42:43] op_sel:[0,0] op_sel_hi:[0,1]
    v_pk_mul_f32 v[26:27], v[8:9], v[10:11] op_sel:[0,0] op_sel_hi:[0,1]
    v_pk_mul_f32 v[58:59], v[40:41], v[42:43] op_sel:[0,0] op_sel_hi:[0,1]
    v_pk_fma_f32 v[12:13], v[106:107], v[86:87], v[12:13] op_sel:[1,1,0] op_sel_hi:[1,0,1] neg_lo:[0,1,0]
    v_pk_fma_f32 v[44:45], v[146:147], v[126:127], v[44:45] op_sel:[1,1,0] op_sel_hi:[1,0,1] neg_lo:[0,1,0]
    v_pk_fma_f32 v[14:15], v[2:3], v[86:87], v[14:15] op_sel:[1,1,0] op_sel_hi:[1,0,1] neg_lo:[0,1,0]
    v_pk_fma_f32 v[46:47], v[34:35], v[126:127], v[46:47] op_sel:[1,1,0] op_sel_hi:[1,0,1] neg_lo:[0,1,0]
    v_pk_fma_f32 v[16:17], v[6:7], v[86:87], v[16:17] op_sel:[1,1,0] op_sel_hi:[1,0,1] neg_lo:[0,1,0]
    v_pk_fma_f32 v[48:49], v[38:39], v[126:127], v[48:49] op_sel:[1,1,0] op_sel_hi:[1,0,1] neg_lo:[0,1,0]
    v_pk_fma_f32 v[18:19], v[8:9], v[86:87], v[18:19] op_sel:[1,1,0] op_sel_hi:[1,0,1] neg_lo:[0,1,0]
    v_pk_fma_f32 v[50:51], v[40:41], v[126:127], v[50:51] op_sel:[1,1,0] op_sel_hi:[1,0,1] neg_lo:[0,1,0]
    v_pk_fma_f32 v[20:21], v[92:93], v[10:11], v[20:21] op_sel:[1,1,0] op_sel_hi:[1,0,1] neg_lo:[0,1,0]
    v_pk_fma_f32 v[52:53], v[132:133], v[42:43], v[52:53] op_sel:[1,1,0] op_sel_hi:[1,0,1] neg_lo:[0,1,0]
    v_pk_fma_f32 v[22:23], v[100:101], v[10:11], v[22:23] op_sel:[1,1,0] op_sel_hi:[1,0,1] neg_lo:[0,1,0]
    v_pk_fma_f32 v[54:55], v[140:141], v[42:43], v[54:55] op_sel:[1,1,0] op_sel_hi:[1,0,1] neg_lo:[0,1,0]
    v_pk_fma_f32 v[24:25], v[6:7], v[10:11], v[24:25] op_sel:[1,1,0] op_sel_hi:[1,0,1] neg_lo:[0,1,0]
    v_pk_fma_f32 v[56:57], v[38:39], v[42:43], v[56:57] op_sel:[1,1,0] op_sel_hi:[1,0,1] neg_lo:[0,1,0]
    v_pk_fma_f32 v[26:27], v[8:9], v[10:11], v[26:27] op_sel:[1,1,0] op_sel_hi:[1,0,1] neg_lo:[0,1,0]
    v_pk_fma_f32 v[58:59], v[40:41], v[42:43], v[58:59] op_sel:[1,1,0] op_sel_hi:[1,0,1] neg_lo:[0,1,0]
    v_cvt_pk_bf16_f32 v168, v12, v13
    v_cvt_pk_bf16_f32 v169, v44, v45
    v_cvt_pk_bf16_f32 v170, v14, v15
    v_cvt_pk_bf16_f32 v171, v46, v47
    v_cvt_pk_bf16_f32 v172, v16, v17
    v_cvt_pk_bf16_f32 v173, v48, v49
    v_cvt_pk_bf16_f32 v174, v18, v19
    v_cvt_pk_bf16_f32 v175, v50, v51
    ds_write_b64 v75, v[168:169] offset:3696
    ds_write_b64 v75, v[170:171] offset:5808
    ds_write_b64 v75, v[172:173] offset:6864
    ds_write_b64 v75, v[174:175] offset:7920
    v_cvt_pk_bf16_f32 v160, v20, v21
    v_cvt_pk_bf16_f32 v161, v52, v53
    v_cvt_pk_bf16_f32 v162, v22, v23
    v_cvt_pk_bf16_f32 v163, v54, v55
    v_cvt_pk_bf16_f32 v164, v24, v25
    v_cvt_pk_bf16_f32 v165, v56, v57
    v_cvt_pk_bf16_f32 v166, v26, v27
    v_cvt_pk_bf16_f32 v167, v58, v59
    ds_write_b64 v75, v[160:161] offset:8448
    ds_write_b64 v75, v[162:163] offset:8976
    ds_write_b64 v75, v[164:165] offset:9504
    ds_write_b64 v75, v[166:167] offset:10032
    v_pk_mul_f32 v[28:29], v[20:21], v[10:11] op_sel:[0,0] op_sel_hi:[0,1]
    v_pk_mul_f32 v[60:61], v[52:53], v[42:43] op_sel:[0,0] op_sel_hi:[0,1]
    v_pk_fma_f32 v[28:29], v[20:21], v[10:11], v[28:29] op_sel:[1,1,0] op_sel_hi:[1,0,1] neg_lo:[0,1,0]
    v_pk_fma_f32 v[60:61], v[52:53], v[42:43], v[60:61] op_sel:[1,1,0] op_sel_hi:[1,0,1] neg_lo:[0,1,0]
    v_cvt_pk_bf16_f32 v168, v28, v29
    v_cvt_pk_bf16_f32 v169, v60, v61
    ds_write_b64 v75, v[168:169] offset:10560
    s_waitcnt lgkmcnt(0)
    ds_read_b128 v[2:5], v156 offset:0
    ds_read_b128 v[6:9], v156 offset:32
    ds_read_b128 v[10:13], v156 offset:64
    ds_read_b128 v[14:17], v156 offset:96
    ds_read_b128 v[18:21], v156 offset:128
    ds_read_b128 v[22:25], v156 offset:160
    ds_read_b128 v[26:29], v156 offset:192
    ds_read_b128 v[30:33], v156 offset:224
    ds_read_b128 v[34:37], v156 offset:256
    ds_read_b128 v[38:41], v156 offset:288
    ds_read_b128 v[42:45], v156 offset:320
    ds_read_b128 v[46:49], v156 offset:352
    s_waitcnt lgkmcnt(8)
    ds_read_b128 v[50:53], v156 offset:384
    ds_read_b128 v[54:57], v156 offset:416
    ds_read_b128 v[58:61], v156 offset:448
    ds_read_b128 v[62:65], v156 offset:480
    v_mfma_f32_32x32x16_bf16 a[0:15], v[2:5], v[176:179], 0
    v_mfma_f32_32x32x16_bf16 a[0:15], v[6:9], v[180:183], a[0:15]
    s_add_u32 s21, s66, 7
    s_and_b32 s21, s21, 7
    s_lshl_b32 s22, s21, 8
    s_add_u32 s22, s22, 149568
    s_add_u32 m0, s22, s51
    s_mul_i32 s21, s21, 57344
    s_add_u32 s21, s21, s50
    buffer_load_dword v255, s[16:19], s21 offen lds
    v_mfma_f32_32x32x16_bf16 a[0:15], v[10:13], v[184:187], a[0:15]
    v_mfma_f32_32x32x16_bf16 a[0:15], v[14:17], v[188:191], a[0:15]
    s_waitcnt lgkmcnt(4)
    v_mfma_f32_32x32x16_bf16 a[0:15], v[18:21], v[192:195], a[0:15]
    v_mfma_f32_32x32x16_bf16 a[0:15], v[22:25], v[196:199], a[0:15]
    v_mfma_f32_32x32x16_bf16 a[0:15], v[26:29], v[200:203], a[0:15]
    v_mfma_f32_32x32x16_bf16 a[0:15], v[30:33], v[204:207], a[0:15]
    s_waitcnt lgkmcnt(0)
    v_mfma_f32_32x32x16_bf16 a[0:15], v[34:37], v[208:211], a[0:15]
    v_mfma_f32_32x32x16_bf16 a[0:15], v[38:41], v[212:215], a[0:15]
    v_mfma_f32_32x32x16_bf16 a[0:15], v[42:45], v[216:219], a[0:15]
    v_mfma_f32_32x32x16_bf16 a[0:15], v[46:49], v[220:223], a[0:15]
    s_waitcnt lgkmcnt(0)
    v_mfma_f32_32x32x16_bf16 a[0:15], v[50:53], v[224:227], a[0:15]
    v_mfma_f32_32x32x16_bf16 a[0:15], v[54:57], v[228:231], a[0:15]
    v_mfma_f32_32x32x16_bf16 a[0:15], v[58:61], v[232:235], a[0:15]
    v_mfma_f32_32x32x16_bf16 a[0:15], v[62:65], v[236:239], a[0:15]
    s_mul_i32 s23, s64, 3072
    s_add_u32 s23, s23, 16896
    v_and_b32 v76, 31, v1
    v_lshlrev_b32 v76, 2, v76
    v_lshrrev_b32 v77, 5, v1
    v_lshl_add_u32 v76, v77, 9, v76
    v_add_u32 v76, s23, v76
    s_nop 4
    ds_write_b32 v76, a0 offset:0
    ds_write_b32 v76, a1 offset:128
    ds_write_b32 v76, a2 offset:256
    ds_write_b32 v76, a3 offset:384
    ds_write_b32 v76, a4 offset:1024
    ds_write_b32 v76, a5 offset:1152
    ds_write_b32 v76, a6 offset:1280
    ds_write_b32 v76, a7 offset:1408
    ds_write_b32 v76, a8 offset:2048
    ds_write_b32 v76, a9 offset:2176
    ds_write_b32 v76, a10 offset:2304
    ds_write_b32 v76, a11 offset:2432
    s_waitcnt lgkmcnt(0)
    s_barrier
    v_and_b32 v76, 0xffff, v70
    v_lshrrev_b32 v77, 16, v70
    v_and_b32 v78, 0xffff, v71
    v_lshrrev_b32 v79, 16, v71
    v_and_b32 v80, 0xffff, v72
    v_lshrrev_b32 v81, 16, v72
    v_and_b32 v82, 0xffff, v73
    v_lshrrev_b32 v83, 16, v73
    v_and_b32 v84, 0xffff, v74
    v_cmp_ne_u32 vcc, 0, v0
    v_lshlrev_b32 v85, 4, v0
    ds_read_b32 v86, v76 offset:16896
    ds_read_b32 v87, v77 offset:16896
    ds_read_b32 v88, v78 offset:16896
    ds_read_b32 v89, v79 offset:16896
    ds_read_b32 v90, v80 offset:16896
    ds_read_b32 v91, v81 offset:16896
    ds_read_b32 v92, v82 offset:16896
    ds_read_b32 v93, v83 offset:16896
    ds_read_b32 v94, v84 offset:16896
    s_waitcnt lgkmcnt(4)
    ds_read_b32 v95, v76 offset:19968
    ds_read_b32 v96, v77 offset:19968
    ds_read_b32 v97, v78 offset:19968
    ds_read_b32 v98, v79 offset:19968
    ds_read_b32 v99, v80 offset:19968
    ds_read_b32 v100, v81 offset:19968
    ds_read_b32 v101, v82 offset:19968
    ds_read_b32 v102, v83 offset:19968
    ds_read_b32 v103, v84 offset:19968
    s_waitcnt lgkmcnt(4)
    ds_read_b32 v104, v76 offset:23040
    ds_read_b32 v105, v77 offset:23040
    ds_read_b32 v106, v78 offset:23040
    ds_read_b32 v107, v79 offset:23040
    ds_read_b32 v108, v80 offset:23040
    ds_read_b32 v109, v81 offset:23040
    ds_read_b32 v110, v82 offset:23040
    ds_read_b32 v111, v83 offset:23040
    ds_read_b32 v112, v84 offset:23040
    s_waitcnt lgkmcnt(9)
    v_add_f32 v86, v86, v95
    v_add_f32 v87, v87, v96
    v_add_f32 v88, v88, v97
    v_add_f32 v89, v89, v98
    v_add_f32 v90, v90, v99
    v_add_f32 v91, v91, v100
    v_add_f32 v92, v92, v101
    v_add_f32 v93, v93, v102
    v_add_f32 v94, v94, v103
    s_waitcnt lgkmcnt(4)
    ds_read_b32 v113, v76 offset:26112
    ds_read_b32 v114, v77 offset:26112
    ds_read_b32 v115, v78 offset:26112
    ds_read_b32 v116, v79 offset:26112
    ds_read_b32 v117, v80 offset:26112
    ds_read_b32 v118, v81 offset:26112
    ds_read_b32 v119, v82 offset:26112
    ds_read_b32 v120, v83 offset:26112
    ds_read_b32 v121, v84 offset:26112
    v_mov_b32 v250, 0
    s_cmp_eq_u32 s64, 0
    s_cbranch_scc0 L_w1i
    global_load_dword v251, v250, s[60:61] sc1
L_w1i:
    v_cndmask_b32 v86, 0, v86, vcc
    v_cvt_pk_bf16_f32 v122, v86, v87
    v_cvt_pk_bf16_f32 v126, v87, v88
    v_cvt_pk_bf16_f32 v123, v88, v89
    v_cvt_pk_bf16_f32 v127, v89, v90
    v_cvt_pk_bf16_f32 v124, v90, v91
    v_cvt_pk_bf16_f32 v128, v91, v92
    v_cvt_pk_bf16_f32 v125, v92, v93
    v_cvt_pk_bf16_f32 v129, v93, v94
    ds_write_b128 v85, v[122:125] offset:112
    ds_write_b128 v85, v[126:129] offset:4336
    s_waitcnt lgkmcnt(2)
    v_add_f32 v104, v104, v113
    v_add_f32 v105, v105, v114
    v_add_f32 v106, v106, v115
    v_add_f32 v107, v107, v116
    v_add_f32 v108, v108, v117
    v_add_f32 v109, v109, v118
    v_add_f32 v110, v110, v119
    v_add_f32 v111, v111, v120
    v_add_f32 v112, v112, v121
    v_cndmask_b32 v104, 0, v104, vcc
    v_cvt_pk_bf16_f32 v130, v104, v105
    v_cvt_pk_bf16_f32 v134, v105, v106
    v_cvt_pk_bf16_f32 v131, v106, v107
    v_cvt_pk_bf16_f32 v135, v107, v108
    v_cvt_pk_bf16_f32 v132, v108, v109
    v_cvt_pk_bf16_f32 v136, v109, v110
    v_cvt_pk_bf16_f32 v133, v110, v111
    v_cvt_pk_bf16_f32 v137, v111, v112
    ds_write_b128 v85, v[130:133] offset:8560
    ds_write_b128 v85, v[134:137] offset:12784
    s_cmp_eq_u32 s64, 0
    s_cbranch_scc0 L_w1_skip
    s_mov_b32 s72, 0
    s_branch L_w1_chk
L_w1:
    global_load_dword v251, v250, s[60:61] sc1
    s_add_u32 s72, s72, 1
L_w1_chk:
    s_waitcnt vmcnt(0)
    v_cmp_gt_u32 vcc, 28, v251
    s_cmp_gt_u32 s72, 400000
    s_cbranch_scc1 L_w1_done
    s_cbranch_vccnz L_w1
L_w1_done:
L_w1_skip:
    s_waitcnt lgkmcnt(0)
    s_barrier
    s_mov_b32 s16, s54
    s_and_b32 s17, s55, 0xffff
    s_mov_b32 s18, 1605632
    s_mov_b32 s19, 0x20000
    s_mov_b32 s25, 0
    buffer_load_dwordx4 v[16:19], v254, s[8:11], s25 offen sc1
    s_mov_b32 s25, 4096
    buffer_load_dwordx4 v[20:23], v254, s[8:11], s25 offen sc1
    s_mov_b32 s25, 8192
    buffer_load_dwordx4 v[24:27], v254, s[8:11], s25 offen sc1
    s_mov_b32 s25, 12288
    buffer_load_dwordx4 v[28:31], v254, s[8:11], s25 offen sc1
    s_add_u32 s27, s77, 0
    s_add_u32 m0, s33, 0
    s_nop 0
    buffer_load_dwordx4 v249, s[12:15], s27 offen lds
    s_add_u32 m0, s33, 1024
    s_nop 0
    buffer_load_dwordx4 v249, s[16:19], s27 offen lds
    s_add_u32 s27, s77, 57344
    s_add_u32 m0, s33, 2048
    s_nop 0
    buffer_load_dwordx4 v249, s[12:15], s27 offen lds
    s_add_u32 m0, s33, 3072
    s_nop 0
    buffer_load_dwordx4 v249, s[16:19], s27 offen lds
    s_add_u32 s27, s77, 114688
    s_add_u32 m0, s33, 4096
    s_nop 0
    buffer_load_dwordx4 v249, s[12:15], s27 offen lds
    s_add_u32 m0, s33, 5120
    s_nop 0
    buffer_load_dwordx4 v249, s[16:19], s27 offen lds
    v_lshlrev_b32 v14, 5, v0
    v_add_u32 v14, 149568, v14
    s_waitcnt vmcnt(10)
    ds_read_b128 v[176:179], v14
    ds_read_b128 v[180:183], v14 offset:16
    s_waitcnt vmcnt(6) lgkmcnt(0)
    v_lshlrev_b32 v32, 16, v176
    v_and_b32 v40, 0xffff0000, v176
    v_lshlrev_b32 v33, 16, v177
    v_and_b32 v41, 0xffff0000, v177
    v_lshlrev_b32 v34, 16, v178
    v_and_b32 v42, 0xffff0000, v178
    v_lshlrev_b32 v35, 16, v179
    v_and_b32 v43, 0xffff0000, v179
    v_lshlrev_b32 v36, 16, v180
    v_and_b32 v44, 0xffff0000, v180
    v_lshlrev_b32 v37, 16, v181
    v_and_b32 v45, 0xffff0000, v181
    v_lshlrev_b32 v38, 16, v182
    v_and_b32 v46, 0xffff0000, v182
    v_lshlrev_b32 v39, 16, v183
    v_and_b32 v47, 0xffff0000, v183
    v_fma_f32 v32, v32, v16, -v17
    v_fma_f32 v40, v40, v16, -v17
    v_fma_f32 v33, v33, v18, -v19
    v_fma_f32 v41, v41, v18, -v19
    v_fma_f32 v34, v34, v20, -v21
    v_fma_f32 v42, v42, v20, -v21
    v_fma_f32 v35, v35, v22, -v23
    v_fma_f32 v43, v43, v22, -v23
    v_fma_f32 v36, v36, v24, -v25
    v_fma_f32 v44, v44, v24, -v25
    v_fma_f32 v37, v37, v26, -v27
    v_fma_f32 v45, v45, v26, -v27
    v_fma_f32 v38, v38, v28, -v29
    v_fma_f32 v46, v46, v28, -v29
    v_fma_f32 v39, v39, v30, -v31
    v_fma_f32 v47, v47, v30, -v31
    v_cvt_pk_bf16_f32 v184, v39, v38
    v_cvt_pk_bf16_f32 v185, v37, v36
    v_cvt_pk_bf16_f32 v186, v35, v34
    v_cvt_pk_bf16_f32 v187, v33, v32
    v_cvt_pk_bf16_f32 v188, v47, v46
    v_cvt_pk_bf16_f32 v189, v45, v44
    v_cvt_pk_bf16_f32 v190, v43, v42
    v_cvt_pk_bf16_f32 v191, v41, v40
    v_mov_b32 v48, v185
    v_mov_b32 v49, v186
    ds_write_b128 v240, v[184:187] offset:18624
    ds_write_b64 v241, v[184:185] offset:6216
    ds_write_b64 v240, v[186:187] offset:6208
    ds_write_b32 v241, v184 offset:4
    ds_write_b64 v241, v[48:49] offset:8
    ds_write_b32 v240, v187 offset:0
    ds_write_b32 v241, v184 offset:12428
    ds_write_b64 v240, v[48:49] offset:12416
    ds_write_b32 v240, v187 offset:12424
    s_waitcnt lgkmcnt(4)
    v_mov_b32 v50, v189
    v_mov_b32 v51, v190
    ds_write_b128 v240, v[188:191] offset:43456
    ds_write_b64 v241, v[188:189] offset:31048
    ds_write_b64 v240, v[190:191] offset:31040
    ds_write_b32 v241, v188 offset:24836
    ds_write_b64 v241, v[50:51] offset:24840
    ds_write_b32 v240, v191 offset:24832
    ds_write_b32 v241, v188 offset:37260
    ds_write_b64 v240, v[50:51] offset:37248
    ds_write_b32 v240, v191 offset:37256
    s_lshl_b32 s22, s70, 16
    s_and_b32 s23, s70, 0xffff0000
    v_lshlrev_b32 v192, 16, v176
    v_and_b32 v52, 0xffff0000, v187
    v_fma_f32 v192, v52, s22, v192
    v_lshlrev_b32 v193, 16, v177
    v_lshlrev_b32 v53, 16, v187
    v_fma_f32 v193, v53, s22, v193
    v_lshlrev_b32 v194, 16, v178
    v_and_b32 v52, 0xffff0000, v186
    v_fma_f32 v194, v52, s22, v194
    v_lshlrev_b32 v195, 16, v179
    v_lshlrev_b32 v53, 16, v186
    v_fma_f32 v195, v53, s22, v195
    v_lshlrev_b32 v196, 16, v180
    v_and_b32 v52, 0xffff0000, v185
    v_fma_f32 v196, v52, s22, v196
    v_lshlrev_b32 v197, 16, v181
    v_lshlrev_b32 v53, 16, v185
    v_fma_f32 v197, v53, s22, v197
    v_lshlrev_b32 v198, 16, v182
    v_and_b32 v52, 0xffff0000, v184
    v_fma_f32 v198, v52, s22, v198
    v_lshlrev_b32 v199, 16, v183
    v_lshlrev_b32 v53, 16, v184
    v_fma_f32 v199, v53, s22, v199
    v_and_b32 v200, 0xffff0000, v176
    v_and_b32 v52, 0xffff0000, v191
    v_fma_f32 v200, v52, s23, v200
    v_and_b32 v201, 0xffff0000, v177
    v_lshlrev_b32 v53, 16, v191
    v_fma_f32 v201, v53, s23, v201
    v_and_b32 v202, 0xffff0000, v178
    v_and_b32 v52, 0xffff0000, v190
    v_fma_f32 v202, v52, s23, v202
    v_and_b32 v203, 0xffff0000, v179
    v_lshlrev_b32 v53, 16, v190
    v_fma_f32 v203, v53, s23, v203
    v_and_b32 v204, 0xffff0000, v180
    v_and_b32 v52, 0xffff0000, v189
    v_fma_f32 v204, v52, s23, v204
    v_and_b32 v205, 0xffff0000, v181
    v_lshlrev_b32 v53, 16, v189
    v_fma_f32 v205, v53, s23, v205
    v_and_b32 v206, 0xffff0000, v182
    v_and_b32 v52, 0xffff0000, v188
    v_fma_f32 v206, v52, s23, v206
    v_and_b32 v207, 0xffff0000, v183
    v_lshlrev_b32 v53, 16, v188
    v_fma_f32 v207, v53, s23, v207
    s_waitcnt lgkmcnt(0)
    s_barrier
    ds_read_b128 v[48:51], v247 offset:4480
    ds_read_b128 v[16:19], v246 offset:0
    ds_read_b128 v[52:55], v247 offset:3840
    ds_read_b128 v[20:23], v246 offset:512
    ds_read_b128 v[56:59], v247 offset:3200
    ds_read_b128 v[24:27], v246 offset:1024
    ds_read_b128 v[60:63], v247 offset:2560
    ds_read_b128 v[28:31], v246 offset:1536
    ds_read_b128 v[64:67], v247 offset:1920
    ds_read_b128 v[32:35], v246 offset:2048
    ds_read_b128 v[68:71], v247 offset:1280
    ds_read_b128 v[36:39], v246 offset:2560
    s_waitcnt lgkmcnt(8)
    ds_read_b128 v[72:75], v247 offset:640
    ds_read_b128 v[40:43], v246 offset:3072
    ds_read_b128 v[76:79], v247 offset:0
    ds_read_b128 v[44:47], v246 offset:3584
    s_waitcnt lgkmcnt(0)
    v_mfma_f32_16x16x32_bf16 v[144:147], v[16:19], v[48:51], 0
    v_mfma_f32_16x16x32_bf16 v[148:151], v[16:19], v[52:55], 0
    ds_read_b128 v[112:115], v247 offset:4544
    v_mfma_f32_16x16x32_bf16 v[152:155], v[16:19], v[56:59], 0
    s_add_u32 s27, s77, 172032
    s_add_u32 m0, s33, 6144
    s_nop 0
    buffer_load_dwordx4 v249, s[12:15], s27 offen lds
    v_mfma_f32_16x16x32_bf16 v[156:159], v[16:19], v[60:63], 0
    ds_read_b128 v[80:83], v246 offset:64
    v_mfma_f32_16x16x32_bf16 v[160:163], v[16:19], v[64:67], 0
    v_mfma_f32_16x16x32_bf16 v[164:167], v[16:19], v[68:71], 0
    ds_read_b128 v[116:119], v247 offset:3904
    v_mfma_f32_16x16x32_bf16 v[168:171], v[16:19], v[72:75], 0
    v_mfma_f32_16x16x32_bf16 v[172:175], v[16:19], v[76:79], 0
    ds_read_b128 v[84:87], v246 offset:576
    v_mfma_f32_16x16x32_bf16 v[148:151], v[20:23], v[48:51], v[148:151]
    s_add_u32 m0, s33, 7168
    s_nop 0
    buffer_load_dwordx4 v249, s[16:19], s27 offen lds
    v_mfma_f32_16x16x32_bf16 v[152:155], v[20:23], v[52:55], v[152:155]
    ds_read_b128 v[120:123], v247 offset:3264
    v_mfma_f32_16x16x32_bf16 v[156:159], v[20:23], v[56:59], v[156:159]
    v_mfma_f32_16x16x32_bf16 v[160:163], v[20:23], v[60:63], v[160:163]
    ds_read_b128 v[88:91], v246 offset:1088
    v_mfma_f32_16x16x32_bf16 v[164:167], v[20:23], v[64:67], v[164:167]
    v_mfma_f32_16x16x32_bf16 v[168:171], v[20:23], v[68:71], v[168:171]
    ds_read_b128 v[124:127], v247 offset:2624
    v_mfma_f32_16x16x32_bf16 v[172:175], v[20:23], v[72:75], v[172:175]
    s_add_u32 s27, s77, 229376
    s_add_u32 m0, s33, 8192
    s_nop 0
    buffer_load_dwordx4 v249, s[12:15], s27 offen lds
    v_mfma_f32_16x16x32_bf16 v[152:155], v[24:27], v[48:51], v[152:155]
    ds_read_b128 v[92:95], v246 offset:1600
    v_mfma_f32_16x16x32_bf16 v[156:159], v[24:27], v[52:55], v[156:159]
    v_mfma_f32_16x16x32_bf16 v[160:163], v[24:27], v[56:59], v[160:163]
    ds_read_b128 v[128:131], v247 offset:1984
    v_mfma_f32_16x16x32_bf16 v[164:167], v[24:27], v[60:63], v[164:167]
    v_mfma_f32_16x16x32_bf16 v[168:171], v[24:27], v[64:67], v[168:171]
    ds_read_b128 v[96:99], v246 offset:2112
    v_mfma_f32_16x16x32_bf16 v[172:175], v[24:27], v[68:71], v[172:175]
    s_add_u32 m0, s33, 9216
    s_nop 0
    buffer_load_dwordx4 v249, s[16:19], s27 offen lds
    v_mfma_f32_16x16x32_bf16 v[156:159], v[28:31], v[48:51], v[156:159]
    ds_read_b128 v[132:135], v247 offset:1344
    v_mfma_f32_16x16x32_bf16 v[160:163], v[28:31], v[52:55], v[160:163]
    v_mfma_f32_16x16x32_bf16 v[164:167], v[28:31], v[56:59], v[164:167]
    ds_read_b128 v[100:103], v246 offset:2624
    v_mfma_f32_16x16x32_bf16 v[168:171], v[28:31], v[60:63], v[168:171]
    v_mfma_f32_16x16x32_bf16 v[172:175], v[28:31], v[64:67], v[172:175]
    ds_read_b128 v[136:139], v247 offset:704
    v_mfma_f32_16x16x32_bf16 v[160:163], v[32:35], v[48:51], v[160:163]
    s_add_u32 s27, s77, 286720
    s_add_u32 m0, s33, 10240
    s_nop 0
    buffer_load_dwordx4 v249, s[12:15], s27 offen lds
    v_mfma_f32_16x16x32_bf16 v[164:167], v[32:35], v[52:55], v[164:167]
    ds_read_b128 v[104:107], v246 offset:3136
    v_mfma_f32_16x16x32_bf16 v[168:171], v[32:35], v[56:59], v[168:171]
    v_mfma_f32_16x16x32_bf16 v[172:175], v[32:35], v[60:63], v[172:175]
    ds_read_b128 v[140:143], v247 offset:64
    v_mfma_f32_16x16x32_bf16 v[164:167], v[36:39], v[48:51], v[164:167]
    v_mfma_f32_16x16x32_bf16 v[168:171], v[36:39], v[52:55], v[168:171]
    ds_read_b128 v[108:111], v246 offset:3648
    v_mfma_f32_16x16x32_bf16 v[172:175], v[36:39], v[56:59], v[172:175]
    s_add_u32 m0, s33, 11264
    s_nop 0
    buffer_load_dwordx4 v249, s[16:19], s27 offen lds
    v_mfma_f32_16x16x32_bf16 v[168:171], v[40:43], v[48:51], v[168:171]
    v_mfma_f32_16x16x32_bf16 v[172:175], v[40:43], v[52:55], v[172:175]
    v_mfma_f32_16x16x32_bf16 v[172:175], v[44:47], v[48:51], v[172:175]
    s_waitcnt lgkmcnt(0)
    v_mfma_f32_16x16x32_bf16 v[144:147], v[80:83], v[112:115], v[144:147]
    v_mfma_f32_16x16x32_bf16 v[148:151], v[80:83], v[116:119], v[148:151]
    ds_read_b128 v[48:51], v247 offset:4640
    v_mfma_f32_16x16x32_bf16 v[152:155], v[80:83], v[120:123], v[152:155]
    s_add_u32 s27, s77, 344064
    s_add_u32 m0, s33, 12288
    s_nop 0
    buffer_load_dwordx4 v249, s[12:15], s27 offen lds
    v_mfma_f32_16x16x32_bf16 v[156:159], v[80:83], v[124:127], v[156:159]
    ds_read_b128 v[16:19], v246 offset:128
    v_mfma_f32_16x16x32_bf16 v[160:163], v[80:83], v[128:131], v[160:163]
    v_mfma_f32_16x16x32_bf16 v[164:167], v[80:83], v[132:135], v[164:167]
    ds_read_b128 v[52:55], v247 offset:4000
    v_mfma_f32_16x16x32_bf16 v[168:171], v[80:83], v[136:139], v[168:171]
    v_mfma_f32_16x16x32_bf16 v[172:175], v[80:83], v[140:143], v[172:175]
    ds_read_b128 v[20:23], v246 offset:640
    v_mfma_f32_16x16x32_bf16 v[148:151], v[84:87], v[112:115], v[148:151]
    s_add_u32 m0, s33, 13312
    s_nop 0
    buffer_load_dwordx4 v249, s[16:19], s27 offen lds
    v_mfma_f32_16x16x32_bf16 v[152:155], v[84:87], v[116:119], v[152:155]
    ds_read_b128 v[56:59], v247 offset:3360
    v_mfma_f32_16x16x32_bf16 v[156:159], v[84:87], v[120:123], v[156:159]
    v_mfma_f32_16x16x32_bf16 v[160:163], v[84:87], v[124:127], v[160:163]
    ds_read_b128 v[24:27], v246 offset:1152
    v_mfma_f32_16x16x32_bf16 v[164:167], v[84:87], v[128:131], v[164:167]
    v_mfma_f32_16x16x32_bf16 v[168:171], v[84:87], v[132:135], v[168:171]
    ds_read_b128 v[60:63], v247 offset:2720
    v_mfma_f32_16x16x32_bf16 v[172:175], v[84:87], v[136:139], v[172:175]
    s_add_u32 s27, s77, 401408
    s_add_u32 m0, s33, 14336
    s_nop 0
    buffer_load_dwordx4 v249, s[12:15], s27 offen lds
    v_mfma_f32_16x16x32_bf16 v[152:155], v[88:91], v[112:115], v[152:155]
    ds_read_b128 v[28:31], v246 offset:1664
    v_mfma_f32_16x16x32_bf16 v[156:159], v[88:91], v[116:119], v[156:159]
    v_mfma_f32_16x16x32_bf16 v[160:163], v[88:91], v[120:123], v[160:163]
    ds_read_b128 v[64:67], v247 offset:2080
    v_mfma_f32_16x16x32_bf16 v[164:167], v[88:91], v[124:127], v[164:167]
    v_mfma_f32_16x16x32_bf16 v[168:171], v[88:91], v[128:131], v[168:171]
    ds_read_b128 v[32:35], v246 offset:2176
    v_mfma_f32_16x16x32_bf16 v[172:175], v[88:91], v[132:135], v[172:175]
    s_add_u32 m0, s33, 15360
    s_nop 0
    buffer_load_dwordx4 v249, s[16:19], s27 offen lds
    v_mfma_f32_16x16x32_bf16 v[156:159], v[92:95], v[112:115], v[156:159]
    ds_read_b128 v[68:71], v247 offset:1440
    v_mfma_f32_16x16x32_bf16 v[160:163], v[92:95], v[116:119], v[160:163]
    v_mfma_f32_16x16x32_bf16 v[164:167], v[92:95], v[120:123], v[164:167]
    ds_read_b128 v[36:39], v246 offset:2688
    v_mfma_f32_16x16x32_bf16 v[168:171], v[92:95], v[124:127], v[168:171]
    v_mfma_f32_16x16x32_bf16 v[172:175], v[92:95], v[128:131], v[172:175]
    ds_read_b128 v[72:75], v247 offset:800
    v_mfma_f32_16x16x32_bf16 v[160:163], v[96:99], v[112:115], v[160:163]
    s_add_u32 s27, s77, 458752
    s_add_u32 m0, s33, 16384
    s_nop 0
    buffer_load_dwordx4 v249, s[12:15], s27 offen lds
    v_mfma_f32_16x16x32_bf16 v[164:167], v[96:99], v[116:119], v[164:167]
    ds_read_b128 v[40:43], v246 offset:3200
    v_mfma_f32_16x16x32_bf16 v[168:171], v[96:99], v[120:123], v[168:171]
    v_mfma_f32_16x16x32_bf16 v[172:175], v[96:99], v[124:127], v[172:175]
    ds_read_b128 v[76:79], v247 offset:160
    v_mfma_f32_16x16x32_bf16 v[164:167], v[100:103], v[112:115], v[164:167]
    v_mfma_f32_16x16x32_bf16 v[168:171], v[100:103], v[116:119], v[168:171]
    ds_read_b128 v[44:47], v246 offset:3712
    v_mfma_f32_16x16x32_bf16 v[172:175], v[100:103], v[120:123], v[172:175]
    s_add_u32 m0, s33, 17408
    s_nop 0
    buffer_load_dwordx4 v249, s[16:19], s27 offen lds
    v_mfma_f32_16x16x32_bf16 v[168:171], v[104:107], v[112:115], v[168:171]
    v_mfma_f32_16x16x32_bf16 v[172:175], v[104:107], v[116:119], v[172:175]
    v_mfma_f32_16x16x32_bf16 v[172:175], v[108:111], v[112:115], v[172:175]
    s_waitcnt lgkmcnt(0)
    v_mfma_f32_16x16x32_bf16 v[144:147], v[16:19], v[48:51], v[144:147]
    s_waitcnt vmcnt(17)
    ds_read_b64_tr_b16 a[0:1], v253 offset:0
    ds_read_b64_tr_b16 a[2:3], v253 offset:256
    v_mfma_f32_16x16x32_bf16 v[148:151], v[16:19], v[52:55], v[148:151]
    ds_read_b128 v[112:115], v247 offset:4704
    v_mfma_f32_16x16x32_bf16 v[152:155], v[16:19], v[56:59], v[152:155]
    v_mfma_f32_16x16x32_bf16 v[156:159], v[16:19], v[60:63], v[156:159]
    ds_read_b128 v[80:83], v246 offset:192
    v_mfma_f32_16x16x32_bf16 v[160:163], v[16:19], v[64:67], v[160:163]
    s_waitcnt vmcnt(16)
    ds_read_b64_tr_b16 a[4:5], v253 offset:1024
    ds_read_b64_tr_b16 a[6:7], v253 offset:1280
    v_mfma_f32_16x16x32_bf16 v[164:167], v[16:19], v[68:71], v[164:167]
    ds_read_b128 v[116:119], v247 offset:4064
    v_mfma_f32_16x16x32_bf16 v[168:171], v[16:19], v[72:75], v[168:171]
    v_mfma_f32_16x16x32_bf16 v[172:175], v[16:19], v[76:79], v[172:175]
    ds_read_b128 v[84:87], v246 offset:704
    v_mfma_f32_16x16x32_bf16 v[148:151], v[20:23], v[48:51], v[148:151]
    s_waitcnt vmcnt(15)
    ds_read_b64_tr_b16 a[8:9], v253 offset:2048
    ds_read_b64_tr_b16 a[10:11], v253 offset:2304
    v_mfma_f32_16x16x32_bf16 v[152:155], v[20:23], v[52:55], v[152:155]
    ds_read_b128 v[120:123], v247 offset:3424
    v_mfma_f32_16x16x32_bf16 v[156:159], v[20:23], v[56:59], v[156:159]
    v_mfma_f32_16x16x32_bf16 v[160:163], v[20:23], v[60:63], v[160:163]
    ds_read_b128 v[88:91], v246 offset:1216
    v_mfma_f32_16x16x32_bf16 v[164:167], v[20:23], v[64:67], v[164:167]
    s_waitcnt vmcnt(14)
    ds_read_b64_tr_b16 a[12:13], v253 offset:3072
    ds_read_b64_tr_b16 a[14:15], v253 offset:3328
    v_mfma_f32_16x16x32_bf16 v[168:171], v[20:23], v[68:71], v[168:171]
    ds_read_b128 v[124:127], v247 offset:2784
    v_mfma_f32_16x16x32_bf16 v[172:175], v[20:23], v[72:75], v[172:175]
    v_mfma_f32_16x16x32_bf16 v[152:155], v[24:27], v[48:51], v[152:155]
    ds_read_b128 v[92:95], v246 offset:1728
    v_mfma_f32_16x16x32_bf16 v[156:159], v[24:27], v[52:55], v[156:159]
    s_waitcnt vmcnt(13)
    ds_read_b64_tr_b16 a[16:17], v253 offset:4096
    ds_read_b64_tr_b16 a[18:19], v253 offset:4352
    v_mfma_f32_16x16x32_bf16 v[160:163], v[24:27], v[56:59], v[160:163]
    ds_read_b128 v[128:131], v247 offset:2144
    v_mfma_f32_16x16x32_bf16 v[164:167], v[24:27], v[60:63], v[164:167]
    v_mfma_f32_16x16x32_bf16 v[168:171], v[24:27], v[64:67], v[168:171]
    ds_read_b128 v[96:99], v246 offset:2240
    v_mfma_f32_16x16x32_bf16 v[172:175], v[24:27], v[68:71], v[172:175]
    s_waitcnt vmcnt(12)
    ds_read_b64_tr_b16 a[20:21], v253 offset:5120
    ds_read_b64_tr_b16 a[22:23], v253 offset:5376
    v_mfma_f32_16x16x32_bf16 v[156:159], v[28:31], v[48:51], v[156:159]
    ds_read_b128 v[132:135], v247 offset:1504
    v_mfma_f32_16x16x32_bf16 v[160:163], v[28:31], v[52:55], v[160:163]
    v_mfma_f32_16x16x32_bf16 v[164:167], v[28:31], v[56:59], v[164:167]
    ds_read_b128 v[100:103], v246 offset:2752
    v_mfma_f32_16x16x32_bf16 v[168:171], v[28:31], v[60:63], v[168:171]
    s_waitcnt vmcnt(11)
    ds_read_b64_tr_b16 a[24:25], v253 offset:6144
    ds_read_b64_tr_b16 a[26:27], v253 offset:6400
    v_mfma_f32_16x16x32_bf16 v[172:175], v[28:31], v[64:67], v[172:175]
    ds_read_b128 v[136:139], v247 offset:864
    v_mfma_f32_16x16x32_bf16 v[160:163], v[32:35], v[48:51], v[160:163]
    v_mfma_f32_16x16x32_bf16 v[164:167], v[32:35], v[52:55], v[164:167]
    ds_read_b128 v[104:107], v246 offset:3264
    v_mfma_f32_16x16x32_bf16 v[168:171], v[32:35], v[56:59], v[168:171]
    s_waitcnt vmcnt(10)
    ds_read_b64_tr_b16 a[28:29], v253 offset:7168
    ds_read_b64_tr_b16 a[30:31], v253 offset:7424
    v_mfma_f32_16x16x32_bf16 v[172:175], v[32:35], v[60:63], v[172:175]
    ds_read_b128 v[140:143], v247 offset:224
    v_mfma_f32_16x16x32_bf16 v[164:167], v[36:39], v[48:51], v[164:167]
    v_mfma_f32_16x16x32_bf16 v[168:171], v[36:39], v[52:55], v[168:171]
    ds_read_b128 v[108:111], v246 offset:3776
    v_mfma_f32_16x16x32_bf16 v[172:175], v[36:39], v[56:59], v[172:175]
    s_waitcnt vmcnt(9)
    ds_read_b64_tr_b16 a[32:33], v253 offset:8192
    ds_read_b64_tr_b16 a[34:35], v253 offset:8448
    v_mfma_f32_16x16x32_bf16 v[168:171], v[40:43], v[48:51], v[168:171]
    v_mfma_f32_16x16x32_bf16 v[172:175], v[40:43], v[52:55], v[172:175]
    v_mfma_f32_16x16x32_bf16 v[172:175], v[44:47], v[48:51], v[172:175]
    s_waitcnt lgkmcnt(0)
    v_mfma_f32_16x16x32_bf16 v[144:147], v[80:83], v[112:115], v[144:147]
    s_add_u32 s27, s77, 516096
    s_add_u32 m0, s33, 0
    s_nop 0
    buffer_load_dwordx4 v249, s[12:15], s27 offen lds
    v_mfma_f32_16x16x32_bf16 v[148:151], v[80:83], v[116:119], v[148:151]
    v_mfma_f32_16x16x32_bf16 v[152:155], v[80:83], v[120:123], v[152:155]
    s_waitcnt vmcnt(9)
    ds_read_b64_tr_b16 a[36:37], v253 offset:9216
    ds_read_b64_tr_b16 a[38:39], v253 offset:9472
    v_mfma_f32_16x16x32_bf16 v[156:159], v[80:83], v[124:127], v[156:159]
    v_mfma_f32_16x16x32_bf16 v[160:163], v[80:83], v[128:131], v[160:163]
    s_add_u32 m0, s33, 1024
    s_nop 0
    buffer_load_dwordx4 v249, s[16:19], s27 offen lds
    v_mfma_f32_16x16x32_bf16 v[164:167], v[80:83], v[132:135], v[164:167]
    v_mfma_f32_16x16x32_bf16 v[168:171], v[80:83], v[136:139], v[168:171]
    s_waitcnt vmcnt(9)
    ds_read_b64_tr_b16 a[40:41], v253 offset:10240
    ds_read_b64_tr_b16 a[42:43], v253 offset:10496
    v_mfma_f32_16x16x32_bf16 v[172:175], v[80:83], v[140:143], v[172:175]
    v_mfma_f32_16x16x32_bf16 v[148:151], v[84:87], v[112:115], v[148:151]
    s_add_u32 s27, s77, 573440
    s_add_u32 m0, s33, 2048
    s_nop 0
    buffer_load_dwordx4 v249, s[12:15], s27 offen lds
    v_mfma_f32_16x16x32_bf16 v[152:155], v[84:87], v[116:119], v[152:155]
    v_mfma_f32_16x16x32_bf16 v[156:159], v[84:87], v[120:123], v[156:159]
    s_waitcnt vmcnt(9)
    ds_read_b64_tr_b16 a[44:45], v253 offset:11264
    ds_read_b64_tr_b16 a[46:47], v253 offset:11520
    v_mfma_f32_16x16x32_bf16 v[160:163], v[84:87], v[124:127], v[160:163]
    v_mfma_f32_16x16x32_bf16 v[164:167], v[84:87], v[128:131], v[164:167]
    s_add_u32 m0, s33, 3072
    s_nop 0
    buffer_load_dwordx4 v249, s[16:19], s27 offen lds
    v_mfma_f32_16x16x32_bf16 v[168:171], v[84:87], v[132:135], v[168:171]
    v_mfma_f32_16x16x32_bf16 v[172:175], v[84:87], v[136:139], v[172:175]
    s_waitcnt vmcnt(9)
    ds_read_b64_tr_b16 a[48:49], v253 offset:12288
    ds_read_b64_tr_b16 a[50:51], v253 offset:12544
    v_mfma_f32_16x16x32_bf16 v[152:155], v[88:91], v[112:115], v[152:155]
    v_mfma_f32_16x16x32_bf16 v[156:159], v[88:91], v[116:119], v[156:159]
    s_add_u32 s27, s77, 630784
    s_add_u32 m0, s33, 4096
    s_nop 0
    buffer_load_dwordx4 v249, s[12:15], s27 offen lds
    v_mfma_f32_16x16x32_bf16 v[160:163], v[88:91], v[120:123], v[160:163]
    v_mfma_f32_16x16x32_bf16 v[164:167], v[88:91], v[124:127], v[164:167]
    s_waitcnt vmcnt(9)
    ds_read_b64_tr_b16 a[52:53], v253 offset:13312
    ds_read_b64_tr_b16 a[54:55], v253 offset:13568
    v_mfma_f32_16x16x32_bf16 v[168:171], v[88:91], v[128:131], v[168:171]
    v_mfma_f32_16x16x32_bf16 v[172:175], v[88:91], v[132:135], v[172:175]
    v_mfma_f32_16x16x32_bf16 v[156:159], v[92:95], v[112:115], v[156:159]
    v_mfma_f32_16x16x32_bf16 v[160:163], v[92:95], v[116:119], v[160:163]
    s_waitcnt vmcnt(8)
    ds_read_b64_tr_b16 a[56:57], v253 offset:14336
    ds_read_b64_tr_b16 a[58:59], v253 offset:14592
    v_mfma_f32_16x16x32_bf16 v[164:167], v[92:95], v[120:123], v[164:167]
    v_mfma_f32_16x16x32_bf16 v[168:171], v[92:95], v[124:127], v[168:171]
    v_mfma_f32_16x16x32_bf16 v[172:175], v[92:95], v[128:131], v[172:175]
    v_mfma_f32_16x16x32_bf16 v[160:163], v[96:99], v[112:115], v[160:163]
    s_waitcnt vmcnt(7)
    ds_read_b64_tr_b16 a[60:61], v253 offset:15360
    ds_read_b64_tr_b16 a[62:63], v253 offset:15616
    v_mfma_f32_16x16x32_bf16 v[164:167], v[96:99], v[116:119], v[164:167]
    v_mfma_f32_16x16x32_bf16 v[168:171], v[96:99], v[120:123], v[168:171]
    v_mfma_f32_16x16x32_bf16 v[172:175], v[96:99], v[124:127], v[172:175]
    v_mfma_f32_16x16x32_bf16 v[164:167], v[100:103], v[112:115], v[164:167]
    s_waitcnt vmcnt(6)
    ds_read_b64_tr_b16 a[64:65], v253 offset:16384
    ds_read_b64_tr_b16 a[66:67], v253 offset:16640
    v_mfma_f32_16x16x32_bf16 v[168:171], v[100:103], v[116:119], v[168:171]
    v_mfma_f32_16x16x32_bf16 v[172:175], v[100:103], v[120:123], v[172:175]
    v_mfma_f32_16x16x32_bf16 v[168:171], v[104:107], v[112:115], v[168:171]
    v_mfma_f32_16x16x32_bf16 v[172:175], v[104:107], v[116:119], v[172:175]
    s_waitcnt vmcnt(5)
    ds_read_b64_tr_b16 a[68:69], v253 offset:17408
    ds_read_b64_tr_b16 a[70:71], v253 offset:17664
    v_mfma_f32_16x16x32_bf16 v[172:175], v[108:111], v[112:115], v[172:175]
    s_barrier
    ds_write_b64 v248, v[144:145] offset:0
    ds_write_b64 v248, v[146:147] offset:32
    ds_write_b64 v248, v[148:149] offset:1152
    ds_write_b64 v248, v[150:151] offset:1184
    ds_write_b64 v248, v[152:153] offset:2304
    ds_write_b64 v248, v[154:155] offset:2336
    ds_write_b64 v248, v[156:157] offset:3456
    ds_write_b64 v248, v[158:159] offset:3488
    ds_write_b64 v248, v[160:161] offset:4608
    ds_write_b64 v248, v[162:163] offset:4640
    ds_write_b64 v248, v[164:165] offset:5760
    ds_write_b64 v248, v[166:167] offset:5792
    ds_write_b64 v248, v[168:169] offset:6912
    ds_write_b64 v248, v[170:171] offset:6944
    ds_write_b64 v248, v[172:173] offset:8064
    ds_write_b64 v248, v[174:175] offset:8096
    s_add_u32 m0, s33, 5120
    s_nop 0
    buffer_load_dwordx4 v249, s[16:19], s27 offen lds
    s_add_u32 s27, s77, 688128
    s_add_u32 m0, s33, 6144
    s_nop 0
    buffer_load_dwordx4 v249, s[12:15], s27 offen lds
    s_add_u32 m0, s33, 7168
    s_nop 0
    buffer_load_dwordx4 v249, s[16:19], s27 offen lds
    s_add_u32 s27, s77, 745472
    s_add_u32 m0, s33, 8192
    s_nop 0
    buffer_load_dwordx4 v249, s[12:15], s27 offen lds
    v_lshlrev_b32 v13, 5, v0
    v_lshrrev_b32 v14, 3, v0
    v_lshl_add_u32 v13, v14, 5, v13
    s_lshl_b32 s22, s70, 16
    s_and_b32 s23, s70, 0xffff0000
    s_lshl_b32 s24, s32, 13
    s_add_u32 s24, s24, 4194304
    s_add_u32 s25, s24, 4096
    s_waitcnt lgkmcnt(0)
    s_barrier
    ds_read_b128 v[16:19], v13 offset:0
    ds_read_b128 v[20:23], v13 offset:16
    ds_read_b128 v[24:27], v13 offset:9216
    ds_read_b128 v[28:31], v13 offset:9232
    ds_read_b128 v[48:51], v13 offset:18432
    ds_read_b128 v[52:55], v13 offset:18448
    ds_read_b128 v[56:59], v13 offset:27648
    ds_read_b128 v[60:63], v13 offset:27664
    s_waitcnt lgkmcnt(4)
    v_pk_add_f32 v[16:17], v[16:17], v[24:25]
    v_pk_add_f32 v[18:19], v[18:19], v[26:27]
    v_pk_add_f32 v[20:21], v[20:21], v[28:29]
    v_pk_add_f32 v[22:23], v[22:23], v[30:31]
    v_pk_add_f32 v[16:17], v[16:17], v[192:193]
    v_pk_add_f32 v[18:19], v[18:19], v[194:195]
    v_pk_add_f32 v[20:21], v[20:21], v[196:197]
    v_pk_add_f32 v[22:23], v[22:23], v[198:199]
    v_cvt_pk_bf16_f32 v40, v16, v17
    v_cvt_pk_bf16_f32 v41, v18, v19
    v_cvt_pk_bf16_f32 v42, v20, v21
    v_cvt_pk_bf16_f32 v43, v22, v23
    buffer_store_dwordx4 v[40:43], v254, s[8:11], s24 offen sc1
    s_waitcnt lgkmcnt(0)
    v_pk_add_f32 v[48:49], v[48:49], v[56:57]
    v_pk_add_f32 v[50:51], v[50:51], v[58:59]
    v_pk_add_f32 v[52:53], v[52:53], v[60:61]
    v_pk_add_f32 v[54:55], v[54:55], v[62:63]
    v_pk_add_f32 v[48:49], v[48:49], v[200:201]
    v_pk_add_f32 v[50:51], v[50:51], v[202:203]
    v_pk_add_f32 v[52:53], v[52:53], v[204:205]
    v_pk_add_f32 v[54:55], v[54:55], v[206:207]
    v_cvt_pk_bf16_f32 v72, v48, v49
    v_cvt_pk_bf16_f32 v73, v50, v51
    v_cvt_pk_bf16_f32 v74, v52, v53
    v_cvt_pk_bf16_f32 v75, v54, v55
    buffer_store_dwordx4 v[72:75], v254, s[8:11], s25 offen sc1
    s_add_u32 m0, s33, 9216
    s_nop 0
    buffer_load_dwordx4 v249, s[16:19], s27 offen lds
    s_add_u32 s27, s77, 802816
    s_add_u32 m0, s33, 10240
    s_nop 0
    buffer_load_dwordx4 v249, s[12:15], s27 offen lds
    s_add_u32 m0, s33, 11264
    s_nop 0
    buffer_load_dwordx4 v249, s[16:19], s27 offen lds
    s_add_u32 s27, s77, 860160
    s_add_u32 m0, s33, 12288
    s_nop 0
    buffer_load_dwordx4 v249, s[12:15], s27 offen lds
    s_add_u32 m0, s33, 13312
    s_nop 0
    buffer_load_dwordx4 v249, s[16:19], s27 offen lds
    s_add_u32 s27, s77, 917504
    s_add_u32 m0, s33, 14336
    s_nop 0
    buffer_load_dwordx4 v249, s[12:15], s27 offen lds
    s_add_u32 m0, s33, 15360
    s_nop 0
    buffer_load_dwordx4 v249, s[16:19], s27 offen lds
    s_add_u32 s27, s77, 974848
    s_add_u32 m0, s33, 16384
    s_nop 0
    buffer_load_dwordx4 v249, s[12:15], s27 offen lds
    s_add_u32 m0, s33, 17408
    s_nop 0
    buffer_load_dwordx4 v249, s[16:19], s27 offen lds
    v_mov_b32 v224, s71
    v_mov_b32 v225, s71
    v_mov_b32 v226, s71
    v_mov_b32 v227, s71
    s_waitcnt vmcnt(19)
    ds_read_b64_tr_b16 a[72:73], v253 offset:0
    ds_read_b64_tr_b16 a[74:75], v253 offset:256
    s_waitcnt vmcnt(18)
    ds_read_b64_tr_b16 a[76:77], v253 offset:1024
    ds_read_b64_tr_b16 a[78:79], v253 offset:1280
    s_waitcnt lgkmcnt(6)
    s_waitcnt vmcnt(17)
    ds_read_b64_tr_b16 a[80:81], v253 offset:2048
    ds_read_b64_tr_b16 a[82:83], v253 offset:2304
    s_waitcnt vmcnt(16)
    ds_read_b64_tr_b16 a[84:85], v253 offset:3072
    ds_read_b64_tr_b16 a[86:87], v253 offset:3328
    s_waitcnt vmcnt(15)
    ds_read_b64_tr_b16 a[88:89], v253 offset:4096
    ds_read_b64_tr_b16 a[90:91], v253 offset:4352
    s_waitcnt vmcnt(14)
    ds_read_b64_tr_b16 a[92:93], v253 offset:5120
    ds_read_b64_tr_b16 a[94:95], v253 offset:5376
    s_waitcnt lgkmcnt(6)
    s_waitcnt vmcnt(13)
    ds_read_b64_tr_b16 a[96:97], v253 offset:6144
    ds_read_b64_tr_b16 a[98:99], v253 offset:6400
    s_waitcnt vmcnt(12)
    ds_read_b64_tr_b16 a[100:101], v253 offset:7168
    ds_read_b64_tr_b16 a[102:103], v253 offset:7424
    s_waitcnt vmcnt(11)
    ds_read_b64_tr_b16 a[104:105], v253 offset:8192
    ds_read_b64_tr_b16 a[106:107], v253 offset:8448
    v_mfma_f32_32x32x16_bf16 v[192:207], v[224:227], a[0:3], 0
    v_mfma_f32_32x32x16_bf16 v[208:223], v[224:227], a[4:7], 0
    v_mfma_f32_32x32x16_bf16 v[192:207], v[224:227], a[8:11], v[192:207]
    v_mfma_f32_32x32x16_bf16 v[208:223], v[224:227], a[12:15], v[208:223]
    v_mfma_f32_32x32x16_bf16 v[192:207], v[224:227], a[16:19], v[192:207]
    v_mfma_f32_32x32x16_bf16 v[208:223], v[224:227], a[20:23], v[208:223]
    v_mfma_f32_32x32x16_bf16 v[192:207], v[224:227], a[24:27], v[192:207]
    v_mfma_f32_32x32x16_bf16 v[208:223], v[224:227], a[28:31], v[208:223]
    v_mfma_f32_32x32x16_bf16 v[192:207], v[224:227], a[32:35], v[192:207]
    s_waitcnt vmcnt(9) lgkmcnt(0)
    s_barrier
    s_lshl_b32 s20, s68, 11
    s_add_u32 s20, s20, 20578304
    s_cmp_eq_u32 s64, 0
    s_cbranch_scc0 L_fa_s2
    s_mov_b64 exec, 255
    v_lshlrev_b32 v2, 8, v1
    v_mov_b32 v3, 1
    buffer_atomic_add v3, v2, s[8:11], s20 offen
    s_mov_b64 exec, -1
L_fa_s2:
    s_add_u32 s27, s77, 1032192
    s_add_u32 m0, s33, 0
    s_nop 0
    buffer_load_dwordx4 v249, s[12:15], s27 offen lds
    v_mfma_f32_32x32x16_bf16 v[208:223], v[224:227], a[36:39], v[208:223]
    v_mfma_f32_32x32x16_bf16 v[192:207], v[224:227], a[40:43], v[192:207]
    s_add_u32 m0, s33, 1024
    s_nop 0
    buffer_load_dwordx4 v249, s[16:19], s27 offen lds
    v_mfma_f32_32x32x16_bf16 v[208:223], v[224:227], a[44:47], v[208:223]
    v_mfma_f32_32x32x16_bf16 v[192:207], v[224:227], a[48:51], v[192:207]
    s_add_u32 s27, s77, 1089536
    s_add_u32 m0, s33, 2048
    s_nop 0
    buffer_load_dwordx4 v249, s[12:15], s27 offen lds
    v_mfma_f32_32x32x16_bf16 v[208:223], v[224:227], a[52:55], v[208:223]
    v_mfma_f32_32x32x16_bf16 v[192:207], v[224:227], a[56:59], v[192:207]
    s_add_u32 m0, s33, 3072
    s_nop 0
    buffer_load_dwordx4 v249, s[16:19], s27 offen lds
    v_mfma_f32_32x32x16_bf16 v[208:223], v[224:227], a[60:63], v[208:223]
    v_mfma_f32_32x32x16_bf16 v[192:207], v[224:227], a[64:67], v[192:207]
    s_add_u32 s27, s77, 1146880
    s_add_u32 m0, s33, 4096
    s_nop 0
    buffer_load_dwordx4 v249, s[12:15], s27 offen lds
    v_mfma_f32_32x32x16_bf16 v[208:223], v[224:227], a[68:71], v[208:223]
    v_mfma_f32_32x32x16_bf16 v[192:207], v[224:227], a[72:75], v[192:207]
    s_add_u32 m0, s33, 5120
    s_nop 0
    buffer_load_dwordx4 v249, s[16:19], s27 offen lds
    v_mfma_f32_32x32x16_bf16 v[208:223], v[224:227], a[76:79], v[208:223]
    v_mfma_f32_32x32x16_bf16 v[192:207], v[224:227], a[80:83], v[192:207]
    s_add_u32 s27, s77, 1204224
    s_add_u32 m0, s33, 6144
    s_nop 0
    buffer_load_dwordx4 v249, s[12:15], s27 offen lds
    v_mfma_f32_32x32x16_bf16 v[208:223], v[224:227], a[84:87], v[208:223]
    v_mfma_f32_32x32x16_bf16 v[192:207], v[224:227], a[88:91], v[192:207]
    s_add_u32 m0, s33, 7168
    s_nop 0
    buffer_load_dwordx4 v249, s[16:19], s27 offen lds
    v_mfma_f32_32x32x16_bf16 v[208:223], v[224:227], a[92:95], v[208:223]
    v_mfma_f32_32x32x16_bf16 v[192:207], v[224:227], a[96:99], v[192:207]
    s_add_u32 s27, s77, 1261568
    s_add_u32 m0, s33, 8192
    s_nop 0
    buffer_load_dwordx4 v249, s[12:15], s27 offen lds
    v_mfma_f32_32x32x16_bf16 v[208:223], v[224:227], a[100:103], v[208:223]
    v_mfma_f32_32x32x16_bf16 v[192:207], v[224:227], a[104:107], v[192:207]
    s_waitcnt vmcnt(17)
    ds_read_b64_tr_b16 a[108:109], v253 offset:9216
    ds_read_b64_tr_b16 a[110:111], v253 offset:9472
    s_waitcnt vmcnt(16)
    ds_read_b64_tr_b16 a[112:113], v253 offset:10240
    ds_read_b64_tr_b16 a[114:115], v253 offset:10496
    s_waitcnt vmcnt(15)
    ds_read_b64_tr_b16 a[116:117], v253 offset:11264
    ds_read_b64_tr_b16 a[118:119], v253 offset:11520
    s_waitcnt vmcnt(14)
    ds_read_b64_tr_b16 a[120:121], v253 offset:12288
    ds_read_b64_tr_b16 a[122:123], v253 offset:12544
    s_waitcnt lgkmcnt(6)
    s_waitcnt vmcnt(13)
    ds_read_b64_tr_b16 a[124:125], v253 offset:13312
    ds_read_b64_tr_b16 a[126:127], v253 offset:13568
    s_waitcnt vmcnt(12)
    ds_read_b64_tr_b16 a[128:129], v253 offset:14336
    ds_read_b64_tr_b16 a[130:131], v253 offset:14592
    s_waitcnt vmcnt(11)
    ds_read_b64_tr_b16 a[132:133], v253 offset:15360
    ds_read_b64_tr_b16 a[134:135], v253 offset:15616
    s_waitcnt vmcnt(10)
    ds_read_b64_tr_b16 a[136:137], v253 offset:16384
    ds_read_b64_tr_b16 a[138:139], v253 offset:16640
    s_waitcnt lgkmcnt(6)
    s_waitcnt vmcnt(9)
    ds_read_b64_tr_b16 a[140:141], v253 offset:17408
    ds_read_b64_tr_b16 a[142:143], v253 offset:17664
    s_waitcnt lgkmcnt(0)
    s_add_u32 m0, s33, 9216
    s_nop 0
    buffer_load_dwordx4 v249, s[16:19], s27 offen lds
    v_mfma_f32_32x32x16_bf16 v[208:223], v[224:227], a[108:111], v[208:223]
    v_mfma_f32_32x32x16_bf16 v[192:207], v[224:227], a[112:115], v[192:207]
    s_add_u32 s27, s77, 1318912
    s_add_u32 m0, s33, 10240
    s_nop 0
    buffer_load_dwordx4 v249, s[12:15], s27 offen lds
    v_mfma_f32_32x32x16_bf16 v[208:223], v[224:227], a[116:119], v[208:223]
    v_mfma_f32_32x32x16_bf16 v[192:207], v[224:227], a[120:123], v[192:207]
    s_add_u32 m0, s33, 11264
    s_nop 0
    buffer_load_dwordx4 v249, s[16:19], s27 offen lds
    v_mfma_f32_32x32x16_bf16 v[208:223], v[224:227], a[124:127], v[208:223]
    v_mfma_f32_32x32x16_bf16 v[192:207], v[224:227], a[128:131], v[192:207]
    s_add_u32 s27, s77, 1376256
    s_add_u32 m0, s33, 12288
    s_nop 0
    buffer_load_dwordx4 v249, s[12:15], s27 offen lds
    v_mfma_f32_32x32x16_bf16 v[208:223], v[224:227], a[132:135], v[208:223]
    s_add_u32 m0, s33, 13312
    s_nop 0
    buffer_load_dwordx4 v249, s[16:19], s27 offen lds
    s_add_u32 s27, s77, 1433600
    s_add_u32 m0, s33, 14336
    s_nop 0
    buffer_load_dwordx4 v249, s[12:15], s27 offen lds
    s_add_u32 m0, s33, 15360
    s_nop 0
    buffer_load_dwordx4 v249, s[16:19], s27 offen lds
    s_add_u32 s27, s77, 1490944
    s_add_u32 m0, s33, 16384
    s_nop 0
    buffer_load_dwordx4 v249, s[12:15], s27 offen lds
    s_add_u32 m0, s33, 17408
    s_nop 0
    buffer_load_dwordx4 v249, s[16:19], s27 offen lds
    s_waitcnt vmcnt(17)
    ds_read_b64_tr_b16 a[144:145], v253 offset:0
    ds_read_b64_tr_b16 a[146:147], v253 offset:256
    s_waitcnt vmcnt(16)
    ds_read_b64_tr_b16 a[148:149], v253 offset:1024
    ds_read_b64_tr_b16 a[150:151], v253 offset:1280
    s_waitcnt vmcnt(15)
    ds_read_b64_tr_b16 a[152:153], v253 offset:2048
    ds_read_b64_tr_b16 a[154:155], v253 offset:2304
    s_waitcnt vmcnt(14)
    ds_read_b64_tr_b16 a[156:157], v253 offset:3072
    ds_read_b64_tr_b16 a[158:159], v253 offset:3328
    s_waitcnt lgkmcnt(6)
    s_waitcnt vmcnt(13)
    ds_read_b64_tr_b16 a[160:161], v253 offset:4096
    ds_read_b64_tr_b16 a[162:163], v253 offset:4352
    s_waitcnt vmcnt(12)
    ds_read_b64_tr_b16 a[164:165], v253 offset:5120
    ds_read_b64_tr_b16 a[166:167], v253 offset:5376
    s_waitcnt vmcnt(11)
    ds_read_b64_tr_b16 a[168:169], v253 offset:6144
    ds_read_b64_tr_b16 a[170:171], v253 offset:6400
    s_waitcnt vmcnt(10)
    ds_read_b64_tr_b16 a[172:173], v253 offset:7168
    ds_read_b64_tr_b16 a[174:175], v253 offset:7424
    s_waitcnt lgkmcnt(6)
    s_waitcnt vmcnt(9)
    ds_read_b64_tr_b16 a[176:177], v253 offset:8192
    ds_read_b64_tr_b16 a[178:179], v253 offset:8448
    s_waitcnt lgkmcnt(0)
    s_add_u32 s27, s77, 1548288
    s_add_u32 m0, s33, 0
    s_nop 0
    buffer_load_dwordx4 v249, s[12:15], s27 offen lds
    s_add_u32 m0, s33, 1024
    s_nop 0
    buffer_load_dwordx4 v249, s[16:19], s27 offen lds
    v_min_u32 v2, 6, v1
    v_lshlrev_b32 v2, 11, v2
    s_lshl_b32 s20, s65, 8
    s_add_u32 s20, s20, 20578304
    v_mov_b32 v5, 128
    s_cmp_eq_u32 s64, 0
    s_cbranch_scc0 L_w2i
    buffer_load_dword v3, v2, s[8:11], s20 offen sc1
    global_load_dword v4, v5, s[60:61] sc1
L_w2i:
    s_waitcnt vmcnt(10)
    ds_read_b64_tr_b16 a[180:181], v253 offset:9216
    ds_read_b64_tr_b16 a[182:183], v253 offset:9472
    s_waitcnt vmcnt(9)
    ds_read_b64_tr_b16 a[184:185], v253 offset:10240
    ds_read_b64_tr_b16 a[186:187], v253 offset:10496
    s_waitcnt vmcnt(8)
    ds_read_b64_tr_b16 a[188:189], v253 offset:11264
    ds_read_b64_tr_b16 a[190:191], v253 offset:11520
    s_waitcnt vmcnt(7)
    ds_read_b64_tr_b16 a[192:193], v253 offset:12288
    ds_read_b64_tr_b16 a[194:195], v253 offset:12544
    s_waitcnt lgkmcnt(6)
    s_waitcnt vmcnt(6)
    ds_read_b64_tr_b16 a[196:197], v253 offset:13312
    ds_read_b64_tr_b16 a[198:199], v253 offset:13568
    s_waitcnt vmcnt(5)
    ds_read_b64_tr_b16 a[200:201], v253 offset:14336
    ds_read_b64_tr_b16 a[202:203], v253 offset:14592
    s_waitcnt vmcnt(4)
    ds_read_b64_tr_b16 a[204:205], v253 offset:15360
    ds_read_b64_tr_b16 a[206:207], v253 offset:15616
    s_waitcnt vmcnt(3)
    ds_read_b64_tr_b16 a[208:209], v253 offset:16384
    ds_read_b64_tr_b16 a[210:211], v253 offset:16640
    s_waitcnt lgkmcnt(6)
    s_waitcnt vmcnt(2)
    ds_read_b64_tr_b16 a[212:213], v253 offset:17408
    ds_read_b64_tr_b16 a[214:215], v253 offset:17664
    s_waitcnt lgkmcnt(0)
    s_waitcnt vmcnt(1)
    ds_read_b64_tr_b16 a[216:217], v253 offset:0
    ds_read_b64_tr_b16 a[218:219], v253 offset:256
    s_waitcnt vmcnt(0)
    ds_read_b64_tr_b16 a[220:221], v253 offset:1024
    ds_read_b64_tr_b16 a[222:223], v253 offset:1280
    s_waitcnt lgkmcnt(0)
    s_cmp_eq_u32 s64, 0
    s_cbranch_scc0 L_w2_skip
    s_mov_b32 s72, 0
    s_branch L_w2_chk
L_w2:
    buffer_load_dword v3, v2, s[8:11], s20 offen sc1
    global_load_dword v4, v5, s[60:61] sc1
    s_add_u32 s72, s72, 1
L_w2_chk:
    s_waitcnt vmcnt(0)
    v_cmp_gt_u32 s[28:29], 28, v4
    v_cmp_gt_u32 vcc, 32, v3
    s_cmp_gt_u32 s72, 400000
    s_cbranch_scc1 L_w2_done
    s_or_b64 vcc, vcc, s[28:29]
    s_cbranch_vccnz L_w2
L_w2_done:
L_w2_skip:
    s_barrier
    v_lshrrev_b32 v2, 4, v1
    v_lshlrev_b32 v3, 2, v2
    v_and_b32 v4, 15, v1
    v_xor_b32 v4, v4, v3
    v_lshlrev_b32 v4, 4, v4
    v_lshl_add_u32 v14, v2, 12, v4
    s_lshl_b32 s20, s73, 8
    s_lshl_b32 s21, s64, 14
    s_add_u32 s20, s20, s21
    s_add_u32 s20, s20, 4194304
    s_lshl_b32 s21, s64, 10
    s_add_u32 s22, s20, 0
    s_add_u32 m0, s21, 0
    s_nop 0
    buffer_load_dwordx4 v14, s[8:11], s22 offen sc1 lds
    s_add_u32 s22, s20, 65536
    s_add_u32 m0, s21, 4096
    s_nop 0
    buffer_load_dwordx4 v14, s[8:11], s22 offen sc1 lds
    s_add_u32 s22, s20, 131072
    s_add_u32 m0, s21, 8192
    s_nop 0
    buffer_load_dwordx4 v14, s[8:11], s22 offen sc1 lds
    v_mfma_f32_32x32x16_bf16 v[192:207], v[224:227], a[136:139], v[192:207]
    v_mfma_f32_32x32x16_bf16 v[208:223], v[224:227], a[140:143], v[208:223]
    s_add_u32 s22, s20, 196608
    s_add_u32 m0, s21, 12288
    s_nop 0
    buffer_load_dwordx4 v14, s[8:11], s22 offen sc1 lds
    v_mfma_f32_32x32x16_bf16 v[192:207], v[224:227], a[144:147], v[192:207]
    v_mfma_f32_32x32x16_bf16 v[208:223], v[224:227], a[148:151], v[208:223]
    s_add_u32 s22, s20, 262144
    s_add_u32 m0, s21, 16384
    s_nop 0
    buffer_load_dwordx4 v14, s[8:11], s22 offen sc1 lds
    v_mfma_f32_32x32x16_bf16 v[192:207], v[224:227], a[152:155], v[192:207]
    v_mfma_f32_32x32x16_bf16 v[208:223], v[224:227], a[156:159], v[208:223]
    s_add_u32 s22, s20, 327680
    s_add_u32 m0, s21, 20480
    s_nop 0
    buffer_load_dwordx4 v14, s[8:11], s22 offen sc1 lds
    v_mfma_f32_32x32x16_bf16 v[192:207], v[224:227], a[160:163], v[192:207]
    v_mfma_f32_32x32x16_bf16 v[208:223], v[224:227], a[164:167], v[208:223]
    s_add_u32 s22, s20, 393216
    s_add_u32 m0, s21, 24576
    s_nop 0
    buffer_load_dwordx4 v14, s[8:11], s22 offen sc1 lds
    v_mfma_f32_32x32x16_bf16 v[192:207], v[224:227], a[168:171], v[192:207]
    v_mfma_f32_32x32x16_bf16 v[208:223], v[224:227], a[172:175], v[208:223]
    s_add_u32 s22, s20, 458752
    s_add_u32 m0, s21, 28672
    s_nop 0
    buffer_load_dwordx4 v14, s[8:11], s22 offen sc1 lds
    v_mfma_f32_32x32x16_bf16 v[192:207], v[224:227], a[176:179], v[192:207]
    v_mfma_f32_32x32x16_bf16 v[208:223], v[224:227], a[180:183], v[208:223]
    s_add_u32 s22, s20, 524288
    s_add_u32 m0, s21, 32768
    s_nop 0
    buffer_load_dwordx4 v14, s[8:11], s22 offen sc1 lds
    v_mfma_f32_32x32x16_bf16 v[192:207], v[224:227], a[184:187], v[192:207]
    v_mfma_f32_32x32x16_bf16 v[208:223], v[224:227], a[188:191], v[208:223]
    s_add_u32 s22, s20, 589824
    s_add_u32 m0, s21, 36864
    s_nop 0
    buffer_load_dwordx4 v14, s[8:11], s22 offen sc1 lds
    v_mfma_f32_32x32x16_bf16 v[192:207], v[224:227], a[192:195], v[192:207]
    v_mfma_f32_32x32x16_bf16 v[208:223], v[224:227], a[196:199], v[208:223]
    s_add_u32 s22, s20, 655360
    s_add_u32 m0, s21, 40960
    s_nop 0
    buffer_load_dwordx4 v14, s[8:11], s22 offen sc1 lds
    v_mfma_f32_32x32x16_bf16 v[192:207], v[224:227], a[200:203], v[192:207]
    v_mfma_f32_32x32x16_bf16 v[208:223], v[224:227], a[204:207], v[208:223]
    s_add_u32 s22, s20, 720896
    s_add_u32 m0, s21, 45056
    s_nop 0
    buffer_load_dwordx4 v14, s[8:11], s22 offen sc1 lds
    v_mfma_f32_32x32x16_bf16 v[192:207], v[224:227], a[208:211], v[192:207]
    v_mfma_f32_32x32x16_bf16 v[208:223], v[224:227], a[212:215], v[208:223]
    s_add_u32 s22, s20, 786432
    s_add_u32 m0, s21, 49152
    s_nop 0
    buffer_load_dwordx4 v14, s[8:11], s22 offen sc1 lds
    v_mfma_f32_32x32x16_bf16 v[192:207], v[224:227], a[216:219], v[192:207]
    v_mfma_f32_32x32x16_bf16 v[208:223], v[224:227], a[220:223], v[208:223]
    s_add_u32 s22, s20, 851968
    s_add_u32 m0, s21, 53248
    s_nop 0
    buffer_load_dwordx4 v14, s[8:11], s22 offen sc1 lds
    s_nop 6
    v_mov_b32 v200, v192
    v_mov_b32 v201, v208
    v_cmp_gt_u32 vcc, 32, v1
    v_cvt_pk_bf16_f32 v202, v200, v200
    v_lshlrev_b32 v203, 16, v202
    v_sub_f32 v203, v200, v203
    v_cvt_pk_bf16_f32 v203, v200, v203
    v_and_b32 v202, 0xffff, v202
    v_cndmask_b32 v192, 0, v203, vcc
    v_cndmask_b32 v193, 0, v202, vcc
    v_mov_b32 v194, 0
    v_mov_b32 v195, 0
    v_cvt_pk_bf16_f32 v202, v201, v201
    v_lshlrev_b32 v203, 16, v202
    v_sub_f32 v203, v201, v203
    v_cvt_pk_bf16_f32 v203, v201, v203
    v_and_b32 v202, 0xffff, v202
    v_cndmask_b32 v196, 0, v203, vcc
    v_cndmask_b32 v197, 0, v202, vcc
    v_mov_b32 v198, 0
    v_mov_b32 v199, 0
    v_mov_b32 v202, 0
    v_mov_b32 v203, 0
    v_lshrrev_b32 v10, 4, v1
    v_and_b32 v11, 15, v1
    v_lshrrev_b32 v12, 2, v11
    v_lshrrev_b32 v13, 1, v10
    v_lshl_add_u32 v13, v13, 3, v12
    v_lshlrev_b32 v13, 8, v13
    v_and_b32 v15, 1, v10
    v_lshl_add_u32 v13, v15, 5, v13
    v_and_b32 v15, 3, v11
    v_lshl_add_u32 v13, v15, 3, v13
    v_xor_b32 v15, 0, v12
    v_lshl_add_u32 v2, v15, 6, v13
    v_add_u32 v6, 0x10000, v2
    v_xor_b32 v15, 1, v12
    v_lshl_add_u32 v3, v15, 6, v13
    v_add_u32 v7, 0x10000, v3
    v_xor_b32 v15, 2, v12
    v_lshl_add_u32 v4, v15, 6, v13
    v_add_u32 v8, 0x10000, v4
    v_xor_b32 v15, 3, v12
    v_lshl_add_u32 v5, v15, 6, v13
    v_add_u32 v9, 0x10000, v5
    v_xor_b32 v15, s64, v12
    v_lshl_add_u32 v10, v15, 6, v13
    v_add_u32 v15, 0x10000, v10
    v_lshlrev_b32 v11, 4, v1
    v_mov_b32 v120, 0
    v_mov_b32 v121, 0
    v_mov_b32 v122, 0
    v_mov_b32 v123, 0
    s_waitcnt vmcnt(7)
    s_barrier
    ds_read_b64_tr_b16 v[140:141], v2 offset:0
    ds_read_b64_tr_b16 v[142:143], v2 offset:1024
    ds_read_b64_tr_b16 v[144:145], v2 offset:4096
    ds_read_b64_tr_b16 v[146:147], v2 offset:5120
    ds_read_b64_tr_b16 v[148:149], v2 offset:8192
    ds_read_b64_tr_b16 v[150:151], v2 offset:9216
    ds_read_b64_tr_b16 v[172:173], v10 offset:0
    ds_read_b64_tr_b16 v[174:175], v10 offset:1024
    s_waitcnt lgkmcnt(6)
    v_mfma_f32_32x32x16_bf16 v[16:31], a[0:3], v[140:143], 0
    ds_read_b64_tr_b16 v[152:153], v2 offset:12288
    ds_read_b64_tr_b16 v[154:155], v2 offset:13312
    s_add_u32 s22, s20, 917504
    s_add_u32 m0, s21, 57344
    s_nop 0
    buffer_load_dwordx4 v14, s[8:11], s22 offen sc1 lds
    v_mfma_f32_32x32x16_bf16 v[32:47], a[4:7], v[140:143], 0
    ds_read_b64_tr_b16 v[176:177], v10 offset:4096
    ds_read_b64_tr_b16 v[178:179], v10 offset:5120
    s_waitcnt lgkmcnt(8)
    v_mfma_f32_32x32x16_bf16 v[16:31], a[8:11], v[144:147], v[16:31]
    ds_read_b64_tr_b16 v[156:157], v2 offset:16384
    ds_read_b64_tr_b16 v[158:159], v2 offset:17408
    s_add_u32 s22, s20, 983040
    s_add_u32 m0, s21, 61440
    s_nop 0
    buffer_load_dwordx4 v14, s[8:11], s22 offen sc1 lds
    v_mfma_f32_32x32x16_bf16 v[32:47], a[12:15], v[144:147], v[32:47]
    ds_read_b64_tr_b16 v[180:181], v10 offset:8192
    ds_read_b64_tr_b16 v[182:183], v10 offset:9216
    s_waitcnt lgkmcnt(10)
    v_mfma_f32_32x32x16_bf16 v[16:31], a[16:19], v[148:151], v[16:31]
    ds_read_b64_tr_b16 v[160:161], v2 offset:20480
    ds_read_b64_tr_b16 v[162:163], v2 offset:21504
    s_add_u32 s22, s20, 1048576
    s_add_u32 m0, s21, 65536
    s_nop 0
    buffer_load_dwordx4 v14, s[8:11], s22 offen sc1 lds
    v_mfma_f32_32x32x16_bf16 v[32:47], a[20:23], v[148:151], v[32:47]
    ds_read_b64_tr_b16 v[184:185], v10 offset:12288
    ds_read_b64_tr_b16 v[186:187], v10 offset:13312
    s_waitcnt lgkmcnt(10)
    v_mfma_f32_32x32x16_bf16 v[16:31], a[24:27], v[152:155], v[16:31]
    ds_read_b64_tr_b16 v[164:165], v2 offset:24576
    ds_read_b64_tr_b16 v[166:167], v2 offset:25600
    s_add_u32 s22, s20, 1114112
    s_add_u32 m0, s21, 69632
    s_nop 0
    buffer_load_dwordx4 v14, s[8:11], s22 offen sc1 lds
    v_mfma_f32_32x32x16_bf16 v[32:47], a[28:31], v[152:155], v[32:47]
    ds_read_b64_tr_b16 v[188:189], v10 offset:16384
    ds_read_b64_tr_b16 v[190:191], v10 offset:17408
    s_waitcnt lgkmcnt(10)
    v_mfma_f32_32x32x16_bf16 v[16:31], a[32:35], v[156:159], v[16:31]
    s_add_u32 s22, s20, 1179648
    s_add_u32 m0, s21, 73728
    s_nop 0
    buffer_load_dwordx4 v14, s[8:11], s22 offen sc1 lds
    v_mfma_f32_32x32x16_bf16 v[32:47], a[36:39], v[156:159], v[32:47]
    ds_read_b64_tr_b16 v[96:97], v10 offset:20480
    ds_read_b64_tr_b16 v[98:99], v10 offset:21504
    s_waitcnt lgkmcnt(8)
    v_mfma_f32_32x32x16_bf16 v[16:31], a[40:43], v[160:163], v[16:31]
    s_add_u32 s22, s20, 1245184
    s_add_u32 m0, s21, 77824
    s_nop 0
    buffer_load_dwordx4 v14, s[8:11], s22 offen sc1 lds
    v_mfma_f32_32x32x16_bf16 v[32:47], a[44:47], v[160:163], v[32:47]
    ds_read_b64_tr_b16 v[100:101], v10 offset:24576
    ds_read_b64_tr_b16 v[102:103], v10 offset:25600
    s_add_u32 s22, s20, 1310720
    s_add_u32 m0, s21, 81920
    s_nop 0
    buffer_load_dwordx4 v14, s[8:11], s22 offen sc1 lds
    s_waitcnt lgkmcnt(6)
    v_mfma_f32_32x32x16_bf16 v[16:31], a[48:51], v[164:167], v[16:31]
    v_mfma_f32_32x32x16_bf16 v[32:47], a[52:55], v[164:167], v[32:47]
    s_waitcnt lgkmcnt(0)
    s_waitcnt vmcnt(7)
    s_barrier
    ds_read_b64_tr_b16 v[140:141], v2 offset:28672
    ds_read_b64_tr_b16 v[142:143], v2 offset:29696
    ds_read_b64_tr_b16 v[144:145], v2 offset:32768
    ds_read_b64_tr_b16 v[146:147], v2 offset:33792
    ds_read_b64_tr_b16 v[148:149], v2 offset:36864
    ds_read_b64_tr_b16 v[150:151], v2 offset:37888
    ds_read_b64_tr_b16 v[204:205], v10 offset:28672
    ds_read_b64_tr_b16 v[206:207], v10 offset:29696
    v_dot2c_f32_bf16 v120, s71, v172
    v_dot2c_f32_bf16 v122, v172, v172
    v_dot2c_f32_bf16 v121, s71, v173
    v_dot2c_f32_bf16 v123, v173, v173
    v_dot2c_f32_bf16 v120, s71, v174
    v_dot2c_f32_bf16 v122, v174, v174
    v_dot2c_f32_bf16 v121, s71, v175
    v_dot2c_f32_bf16 v123, v175, v175
    v_dot2c_f32_bf16 v120, s71, v176
    v_dot2c_f32_bf16 v122, v176, v176
    v_dot2c_f32_bf16 v121, s71, v177
    v_dot2c_f32_bf16 v123, v177, v177
    v_dot2c_f32_bf16 v120, s71, v178
    v_dot2c_f32_bf16 v122, v178, v178
    v_dot2c_f32_bf16 v121, s71, v179
    v_dot2c_f32_bf16 v123, v179, v179
    v_dot2c_f32_bf16 v120, s71, v180
    v_dot2c_f32_bf16 v122, v180, v180
    v_dot2c_f32_bf16 v121, s71, v181
    v_dot2c_f32_bf16 v123, v181, v181
    v_dot2c_f32_bf16 v120, s71, v182
    v_dot2c_f32_bf16 v122, v182, v182
    v_dot2c_f32_bf16 v121, s71, v183
    v_dot2c_f32_bf16 v123, v183, v183
    v_dot2c_f32_bf16 v120, s71, v184
    v_dot2c_f32_bf16 v122, v184, v184
    v_dot2c_f32_bf16 v121, s71, v185
    v_dot2c_f32_bf16 v123, v185, v185
    v_dot2c_f32_bf16 v120, s71, v186
    v_dot2c_f32_bf16 v122, v186, v186
    v_dot2c_f32_bf16 v121, s71, v187
    v_dot2c_f32_bf16 v123, v187, v187
    v_dot2c_f32_bf16 v120, s71, v188
    v_dot2c_f32_bf16 v122, v188, v188
    v_dot2c_f32_bf16 v121, s71, v189
    v_dot2c_f32_bf16 v123, v189, v189
    v_dot2c_f32_bf16 v120, s71, v190
    v_dot2c_f32_bf16 v122, v190, v190
    v_dot2c_f32_bf16 v121, s71, v191
    v_dot2c_f32_bf16 v123, v191, v191
    v_dot2c_f32_bf16 v120, s71, v96
    v_dot2c_f32_bf16 v122, v96, v96
    v_dot2c_f32_bf16 v121, s71, v97
    v_dot2c_f32_bf16 v123, v97, v97
    v_dot2c_f32_bf16 v120, s71, v98
    v_dot2c_f32_bf16 v122, v98, v98
    v_dot2c_f32_bf16 v121, s71, v99
    v_dot2c_f32_bf16 v123, v99, v99
    v_dot2c_f32_bf16 v120, s71, v100
    v_dot2c_f32_bf16 v122, v100, v100
    v_dot2c_f32_bf16 v121, s71, v101
    v_dot2c_f32_bf16 v123, v101, v101
    v_dot2c_f32_bf16 v120, s71, v102
    v_dot2c_f32_bf16 v122, v102, v102
    v_dot2c_f32_bf16 v121, s71, v103
    v_dot2c_f32_bf16 v123, v103, v103
    s_waitcnt lgkmcnt(6)
    v_mfma_f32_32x32x16_bf16 v[16:31], a[56:59], v[140:143], v[16:31]
    ds_read_b64_tr_b16 v[152:153], v2 offset:40960
    ds_read_b64_tr_b16 v[154:155], v2 offset:41984
    s_add_u32 s22, s20, 1376256
    s_add_u32 m0, s21, 86016
    s_nop 0
    buffer_load_dwordx4 v14, s[8:11], s22 offen sc1 lds
    v_mfma_f32_32x32x16_bf16 v[32:47], a[60:63], v[140:143], v[32:47]
    ds_read_b64_tr_b16 v[208:209], v10 offset:32768
    ds_read_b64_tr_b16 v[210:211], v10 offset:33792
    s_waitcnt lgkmcnt(8)
    v_mfma_f32_32x32x16_bf16 v[16:31], a[64:67], v[144:147], v[16:31]
    ds_read_b64_tr_b16 v[156:157], v2 offset:45056
    ds_read_b64_tr_b16 v[158:159], v2 offset:46080
    s_add_u32 s22, s20, 1441792
    s_add_u32 m0, s21, 90112
    s_nop 0
    buffer_load_dwordx4 v14, s[8:11], s22 offen sc1 lds
    v_mfma_f32_32x32x16_bf16 v[32:47], a[68:71], v[144:147], v[32:47]
    ds_read_b64_tr_b16 v[212:213], v10 offset:36864
    ds_read_b64_tr_b16 v[214:215], v10 offset:37888
    s_waitcnt lgkmcnt(10)
    v_mfma_f32_32x32x16_bf16 v[16:31], a[72:75], v[148:151], v[16:31]
    ds_read_b64_tr_b16 v[160:161], v2 offset:49152
    ds_read_b64_tr_b16 v[162:163], v2 offset:50176
    s_add_u32 s22, s20, 1507328
    s_add_u32 m0, s21, 94208
    s_nop 0
    buffer_load_dwordx4 v14, s[8:11], s22 offen sc1 lds
    v_mfma_f32_32x32x16_bf16 v[32:47], a[76:79], v[148:151], v[32:47]
    ds_read_b64_tr_b16 v[216:217], v10 offset:40960
    ds_read_b64_tr_b16 v[218:219], v10 offset:41984
    s_waitcnt lgkmcnt(10)
    v_mfma_f32_32x32x16_bf16 v[16:31], a[80:83], v[152:155], v[16:31]
    ds_read_b64_tr_b16 v[164:165], v2 offset:53248
    ds_read_b64_tr_b16 v[166:167], v2 offset:54272
    s_add_u32 s22, s20, 1572864
    s_add_u32 m0, s21, 98304
    s_nop 0
    buffer_load_dwordx4 v14, s[8:11], s22 offen sc1 lds
    v_mfma_f32_32x32x16_bf16 v[32:47], a[84:87], v[152:155], v[32:47]
    ds_read_b64_tr_b16 v[220:221], v10 offset:45056
    ds_read_b64_tr_b16 v[222:223], v10 offset:46080
    s_waitcnt lgkmcnt(10)
    v_mfma_f32_32x32x16_bf16 v[16:31], a[88:91], v[156:159], v[16:31]
    s_add_u32 s22, s20, 1638400
    s_add_u32 m0, s21, 102400
    s_nop 0
    buffer_load_dwordx4 v14, s[8:11], s22 offen sc1 lds
    v_mfma_f32_32x32x16_bf16 v[32:47], a[92:95], v[156:159], v[32:47]
    ds_read_b64_tr_b16 v[108:109], v10 offset:49152
    ds_read_b64_tr_b16 v[110:111], v10 offset:50176
    s_waitcnt lgkmcnt(8)
    v_mfma_f32_32x32x16_bf16 v[16:31], a[96:99], v[160:163], v[16:31]
    s_add_u32 s22, s20, 1703936
    s_add_u32 m0, s21, 106496
    s_nop 0
    buffer_load_dwordx4 v14, s[8:11], s22 offen sc1 lds
    v_mfma_f32_32x32x16_bf16 v[32:47], a[100:103], v[160:163], v[32:47]
    ds_read_b64_tr_b16 v[124:125], v10 offset:53248
    ds_read_b64_tr_b16 v[126:127], v10 offset:54272
    s_add_u32 s22, s20, 1769472
    s_add_u32 m0, s21, 110592
    s_nop 0
    buffer_load_dwordx4 v14, s[8:11], s22 offen sc1 lds
    s_waitcnt lgkmcnt(6)
    v_mfma_f32_32x32x16_bf16 v[16:31], a[104:107], v[164:167], v[16:31]
    v_mfma_f32_32x32x16_bf16 v[32:47], a[108:111], v[164:167], v[32:47]
    s_waitcnt lgkmcnt(0)
    s_waitcnt vmcnt(7)
    s_barrier
    ds_read_b64_tr_b16 v[140:141], v2 offset:57344
    ds_read_b64_tr_b16 v[142:143], v2 offset:58368
    ds_read_b64_tr_b16 v[144:145], v2 offset:61440
    ds_read_b64_tr_b16 v[146:147], v2 offset:62464
    ds_read_b64_tr_b16 v[148:149], v6 offset:0
    ds_read_b64_tr_b16 v[150:151], v6 offset:1024
    ds_read_b64_tr_b16 v[172:173], v10 offset:57344
    ds_read_b64_tr_b16 v[174:175], v10 offset:58368
    v_dot2c_f32_bf16 v120, s71, v204
    v_dot2c_f32_bf16 v122, v204, v204
    v_dot2c_f32_bf16 v121, s71, v205
    v_dot2c_f32_bf16 v123, v205, v205
    v_dot2c_f32_bf16 v120, s71, v206
    v_dot2c_f32_bf16 v122, v206, v206
    v_dot2c_f32_bf16 v121, s71, v207
    v_dot2c_f32_bf16 v123, v207, v207
    v_dot2c_f32_bf16 v120, s71, v208
    v_dot2c_f32_bf16 v122, v208, v208
    v_dot2c_f32_bf16 v121, s71, v209
    v_dot2c_f32_bf16 v123, v209, v209
    v_dot2c_f32_bf16 v120, s71, v210
    v_dot2c_f32_bf16 v122, v210, v210
    v_dot2c_f32_bf16 v121, s71, v211
    v_dot2c_f32_bf16 v123, v211, v211
    v_dot2c_f32_bf16 v120, s71, v212
    v_dot2c_f32_bf16 v122, v212, v212
    v_dot2c_f32_bf16 v121, s71, v213
    v_dot2c_f32_bf16 v123, v213, v213
    v_dot2c_f32_bf16 v120, s71, v214
    v_dot2c_f32_bf16 v122, v214, v214
    v_dot2c_f32_bf16 v121, s71, v215
    v_dot2c_f32_bf16 v123, v215, v215
    v_dot2c_f32_bf16 v120, s71, v216
    v_dot2c_f32_bf16 v122, v216, v216
    v_dot2c_f32_bf16 v121, s71, v217
    v_dot2c_f32_bf16 v123, v217, v217
    v_dot2c_f32_bf16 v120, s71, v218
    v_dot2c_f32_bf16 v122, v218, v218
    v_dot2c_f32_bf16 v121, s71, v219
    v_dot2c_f32_bf16 v123, v219, v219
    v_dot2c_f32_bf16 v120, s71, v220
    v_dot2c_f32_bf16 v122, v220, v220
    v_dot2c_f32_bf16 v121, s71, v221
    v_dot2c_f32_bf16 v123, v221, v221
    v_dot2c_f32_bf16 v120, s71, v222
    v_dot2c_f32_bf16 v122, v222, v222
    v_dot2c_f32_bf16 v121, s71, v223
    v_dot2c_f32_bf16 v123, v223, v223
    v_dot2c_f32_bf16 v120, s71, v108
    v_dot2c_f32_bf16 v122, v108, v108
    v_dot2c_f32_bf16 v121, s71, v109
    v_dot2c_f32_bf16 v123, v109, v109
    v_dot2c_f32_bf16 v120, s71, v110
    v_dot2c_f32_bf16 v122, v110, v110
    v_dot2c_f32_bf16 v121, s71, v111
    v_dot2c_f32_bf16 v123, v111, v111
    v_dot2c_f32_bf16 v120, s71, v124
    v_dot2c_f32_bf16 v122, v124, v124
    v_dot2c_f32_bf16 v121, s71, v125
    v_dot2c_f32_bf16 v123, v125, v125
    v_dot2c_f32_bf16 v120, s71, v126
    v_dot2c_f32_bf16 v122, v126, v126
    v_dot2c_f32_bf16 v121, s71, v127
    v_dot2c_f32_bf16 v123, v127, v127
    s_waitcnt lgkmcnt(6)
    v_mfma_f32_32x32x16_bf16 v[16:31], a[112:115], v[140:143], v[16:31]
    ds_read_b64_tr_b16 v[152:153], v6 offset:4096
    ds_read_b64_tr_b16 v[154:155], v6 offset:5120
    v_mfma_f32_32x32x16_bf16 v[32:47], a[116:119], v[140:143], v[32:47]
    ds_read_b64_tr_b16 v[176:177], v10 offset:61440
    ds_read_b64_tr_b16 v[178:179], v10 offset:62464
    s_waitcnt lgkmcnt(8)
    v_mfma_f32_32x32x16_bf16 v[16:31], a[120:123], v[144:147], v[16:31]
    ds_read_b64_tr_b16 v[156:157], v6 offset:8192
    ds_read_b64_tr_b16 v[158:159], v6 offset:9216
    v_mfma_f32_32x32x16_bf16 v[32:47], a[124:127], v[144:147], v[32:47]
    ds_read_b64_tr_b16 v[180:181], v15 offset:0
    ds_read_b64_tr_b16 v[182:183], v15 offset:1024
    s_waitcnt lgkmcnt(10)
    v_mfma_f32_32x32x16_bf16 v[16:31], a[128:131], v[148:151], v[16:31]
    ds_read_b64_tr_b16 v[160:161], v6 offset:12288
    ds_read_b64_tr_b16 v[162:163], v6 offset:13312
    v_mfma_f32_32x32x16_bf16 v[32:47], a[132:135], v[148:151], v[32:47]
    ds_read_b64_tr_b16 v[184:185], v15 offset:4096
    ds_read_b64_tr_b16 v[186:187], v15 offset:5120
    s_waitcnt lgkmcnt(10)
    v_mfma_f32_32x32x16_bf16 v[16:31], a[136:139], v[152:155], v[16:31]
    ds_read_b64_tr_b16 v[164:165], v6 offset:16384
    ds_read_b64_tr_b16 v[166:167], v6 offset:17408
    v_mfma_f32_32x32x16_bf16 v[32:47], a[140:143], v[152:155], v[32:47]
    ds_read_b64_tr_b16 v[188:189], v15 offset:8192
    ds_read_b64_tr_b16 v[190:191], v15 offset:9216
    s_waitcnt lgkmcnt(10)
    v_mfma_f32_32x32x16_bf16 v[16:31], a[144:147], v[156:159], v[16:31]
    v_mfma_f32_32x32x16_bf16 v[32:47], a[148:151], v[156:159], v[32:47]
    ds_read_b64_tr_b16 v[96:97], v15 offset:12288
    ds_read_b64_tr_b16 v[98:99], v15 offset:13312
    s_waitcnt lgkmcnt(8)
    v_mfma_f32_32x32x16_bf16 v[16:31], a[152:155], v[160:163], v[16:31]
    v_mfma_f32_32x32x16_bf16 v[32:47], a[156:159], v[160:163], v[32:47]
    ds_read_b64_tr_b16 v[100:101], v15 offset:16384
    ds_read_b64_tr_b16 v[102:103], v15 offset:17408
    s_waitcnt lgkmcnt(6)
    v_mfma_f32_32x32x16_bf16 v[16:31], a[160:163], v[164:167], v[16:31]
    v_mfma_f32_32x32x16_bf16 v[32:47], a[164:167], v[164:167], v[32:47]
    s_waitcnt lgkmcnt(0)
    s_waitcnt vmcnt(0)
    s_barrier
    ds_read_b64_tr_b16 v[140:141], v6 offset:20480
    ds_read_b64_tr_b16 v[142:143], v6 offset:21504
    ds_read_b64_tr_b16 v[144:145], v6 offset:24576
    ds_read_b64_tr_b16 v[146:147], v6 offset:25600
    ds_read_b64_tr_b16 v[148:149], v6 offset:28672
    ds_read_b64_tr_b16 v[150:151], v6 offset:29696
    ds_read_b64_tr_b16 v[204:205], v15 offset:20480
    ds_read_b64_tr_b16 v[206:207], v15 offset:21504
    v_dot2c_f32_bf16 v120, s71, v172
    v_dot2c_f32_bf16 v122, v172, v172
    v_dot2c_f32_bf16 v121, s71, v173
    v_dot2c_f32_bf16 v123, v173, v173
    v_dot2c_f32_bf16 v120, s71, v174
    v_dot2c_f32_bf16 v122, v174, v174
    v_dot2c_f32_bf16 v121, s71, v175
    v_dot2c_f32_bf16 v123, v175, v175
    v_dot2c_f32_bf16 v120, s71, v176
    v_dot2c_f32_bf16 v122, v176, v176
    v_dot2c_f32_bf16 v121, s71, v177
    v_dot2c_f32_bf16 v123, v177, v177
    v_dot2c_f32_bf16 v120, s71, v178
    v_dot2c_f32_bf16 v122, v178, v178
    v_dot2c_f32_bf16 v121, s71, v179
    v_dot2c_f32_bf16 v123, v179, v179
    v_dot2c_f32_bf16 v120, s71, v180
    v_dot2c_f32_bf16 v122, v180, v180
    v_dot2c_f32_bf16 v121, s71, v181
    v_dot2c_f32_bf16 v123, v181, v181
    v_dot2c_f32_bf16 v120, s71, v182
    v_dot2c_f32_bf16 v122, v182, v182
    v_dot2c_f32_bf16 v121, s71, v183
    v_dot2c_f32_bf16 v123, v183, v183
    v_dot2c_f32_bf16 v120, s71, v184
    v_dot2c_f32_bf16 v122, v184, v184
    v_dot2c_f32_bf16 v121, s71, v185
    v_dot2c_f32_bf16 v123, v185, v185
    v_dot2c_f32_bf16 v120, s71, v186
    v_dot2c_f32_bf16 v122, v186, v186
    v_dot2c_f32_bf16 v121, s71, v187
    v_dot2c_f32_bf16 v123, v187, v187
    v_dot2c_f32_bf16 v120, s71, v188
    v_dot2c_f32_bf16 v122, v188, v188
    v_dot2c_f32_bf16 v121, s71, v189
    v_dot2c_f32_bf16 v123, v189, v189
    v_dot2c_f32_bf16 v120, s71, v190
    v_dot2c_f32_bf16 v122, v190, v190
    v_dot2c_f32_bf16 v121, s71, v191
    v_dot2c_f32_bf16 v123, v191, v191
    v_dot2c_f32_bf16 v120, s71, v96
    v_dot2c_f32_bf16 v122, v96, v96
    v_dot2c_f32_bf16 v121, s71, v97
    v_dot2c_f32_bf16 v123, v97, v97
    v_dot2c_f32_bf16 v120, s71, v98
    v_dot2c_f32_bf16 v122, v98, v98
    v_dot2c_f32_bf16 v121, s71, v99
    v_dot2c_f32_bf16 v123, v99, v99
    v_dot2c_f32_bf16 v120, s71, v100
    v_dot2c_f32_bf16 v122, v100, v100
    v_dot2c_f32_bf16 v121, s71, v101
    v_dot2c_f32_bf16 v123, v101, v101
    v_dot2c_f32_bf16 v120, s71, v102
    v_dot2c_f32_bf16 v122, v102, v102
    v_dot2c_f32_bf16 v121, s71, v103
    v_dot2c_f32_bf16 v123, v103, v103
    s_waitcnt lgkmcnt(6)
    v_mfma_f32_32x32x16_bf16 v[16:31], a[168:171], v[140:143], v[16:31]
    ds_read_b64_tr_b16 v[152:153], v6 offset:32768
    ds_read_b64_tr_b16 v[154:155], v6 offset:33792
    v_mfma_f32_32x32x16_bf16 v[32:47], a[172:175], v[140:143], v[32:47]
    ds_read_b64_tr_b16 v[208:209], v15 offset:24576
    ds_read_b64_tr_b16 v[210:211], v15 offset:25600
    s_waitcnt lgkmcnt(8)
    v_mfma_f32_32x32x16_bf16 v[16:31], a[176:179], v[144:147], v[16:31]
    ds_read_b64_tr_b16 v[156:157], v6 offset:36864
    ds_read_b64_tr_b16 v[158:159], v6 offset:37888
    v_mfma_f32_32x32x16_bf16 v[32:47], a[180:183], v[144:147], v[32:47]
    ds_read_b64_tr_b16 v[212:213], v15 offset:28672
    ds_read_b64_tr_b16 v[214:215], v15 offset:29696
    s_waitcnt lgkmcnt(10)
    v_mfma_f32_32x32x16_bf16 v[16:31], a[184:187], v[148:151], v[16:31]
    ds_read_b64_tr_b16 v[160:161], v6 offset:40960
    ds_read_b64_tr_b16 v[162:163], v6 offset:41984
    v_mfma_f32_32x32x16_bf16 v[32:47], a[188:191], v[148:151], v[32:47]
    ds_read_b64_tr_b16 v[216:217], v15 offset:32768
    ds_read_b64_tr_b16 v[218:219], v15 offset:33792
    s_waitcnt lgkmcnt(10)
    v_mfma_f32_32x32x16_bf16 v[16:31], a[192:195], v[152:155], v[16:31]
    ds_read_b64_tr_b16 v[164:165], v6 offset:45056
    ds_read_b64_tr_b16 v[166:167], v6 offset:46080
    v_mfma_f32_32x32x16_bf16 v[32:47], a[196:199], v[152:155], v[32:47]
    ds_read_b64_tr_b16 v[220:221], v15 offset:36864
    ds_read_b64_tr_b16 v[222:223], v15 offset:37888
    s_waitcnt lgkmcnt(10)
    v_mfma_f32_32x32x16_bf16 v[16:31], a[200:203], v[156:159], v[16:31]
    v_mfma_f32_32x32x16_bf16 v[32:47], a[204:207], v[156:159], v[32:47]
    ds_read_b64_tr_b16 v[108:109], v15 offset:40960
    ds_read_b64_tr_b16 v[110:111], v15 offset:41984
    s_waitcnt lgkmcnt(8)
    v_mfma_f32_32x32x16_bf16 v[16:31], a[208:211], v[160:163], v[16:31]
    v_mfma_f32_32x32x16_bf16 v[32:47], a[212:215], v[160:163], v[32:47]
    ds_read_b64_tr_b16 v[124:125], v15 offset:45056
    ds_read_b64_tr_b16 v[126:127], v15 offset:46080
    s_waitcnt lgkmcnt(6)
    v_mfma_f32_32x32x16_bf16 v[16:31], a[216:219], v[164:167], v[16:31]
    v_mfma_f32_32x32x16_bf16 v[32:47], a[220:223], v[164:167], v[32:47]
    s_waitcnt lgkmcnt(0)
    ds_read_b64_tr_b16 v[80:81], v3 offset:0
    ds_read_b64_tr_b16 v[82:83], v3 offset:1024
    ds_read_b64_tr_b16 v[84:85], v3 offset:4096
    ds_read_b64_tr_b16 v[86:87], v3 offset:5120
    ds_read_b64_tr_b16 v[88:89], v3 offset:8192
    ds_read_b64_tr_b16 v[90:91], v3 offset:9216
    v_dot2c_f32_bf16 v120, s71, v204
    v_dot2c_f32_bf16 v122, v204, v204
    v_dot2c_f32_bf16 v121, s71, v205
    v_dot2c_f32_bf16 v123, v205, v205
    v_dot2c_f32_bf16 v120, s71, v206
    v_dot2c_f32_bf16 v122, v206, v206
    v_dot2c_f32_bf16 v121, s71, v207
    v_dot2c_f32_bf16 v123, v207, v207
    v_dot2c_f32_bf16 v120, s71, v208
    v_dot2c_f32_bf16 v122, v208, v208
    v_dot2c_f32_bf16 v121, s71, v209
    v_dot2c_f32_bf16 v123, v209, v209
    v_dot2c_f32_bf16 v120, s71, v210
    v_dot2c_f32_bf16 v122, v210, v210
    v_dot2c_f32_bf16 v121, s71, v211
    v_dot2c_f32_bf16 v123, v211, v211
    v_dot2c_f32_bf16 v120, s71, v212
    v_dot2c_f32_bf16 v122, v212, v212
    v_dot2c_f32_bf16 v121, s71, v213
    v_dot2c_f32_bf16 v123, v213, v213
    v_dot2c_f32_bf16 v120, s71, v214
    v_dot2c_f32_bf16 v122, v214, v214
    v_dot2c_f32_bf16 v121, s71, v215
    v_dot2c_f32_bf16 v123, v215, v215
    v_dot2c_f32_bf16 v120, s71, v216
    v_dot2c_f32_bf16 v122, v216, v216
    v_dot2c_f32_bf16 v121, s71, v217
    v_dot2c_f32_bf16 v123, v217, v217
    v_dot2c_f32_bf16 v120, s71, v218
    v_dot2c_f32_bf16 v122, v218, v218
    v_dot2c_f32_bf16 v121, s71, v219
    v_dot2c_f32_bf16 v123, v219, v219
    v_dot2c_f32_bf16 v120, s71, v220
    v_dot2c_f32_bf16 v122, v220, v220
    v_dot2c_f32_bf16 v121, s71, v221
    v_dot2c_f32_bf16 v123, v221, v221
    v_dot2c_f32_bf16 v120, s71, v222
    v_dot2c_f32_bf16 v122, v222, v222
    v_dot2c_f32_bf16 v121, s71, v223
    v_dot2c_f32_bf16 v123, v223, v223
    v_dot2c_f32_bf16 v120, s71, v108
    v_dot2c_f32_bf16 v122, v108, v108
    v_dot2c_f32_bf16 v121, s71, v109
    v_dot2c_f32_bf16 v123, v109, v109
    v_dot2c_f32_bf16 v120, s71, v110
    v_dot2c_f32_bf16 v122, v110, v110
    v_dot2c_f32_bf16 v121, s71, v111
    v_dot2c_f32_bf16 v123, v111, v111
    v_dot2c_f32_bf16 v120, s71, v124
    v_dot2c_f32_bf16 v122, v124, v124
    v_dot2c_f32_bf16 v121, s71, v125
    v_dot2c_f32_bf16 v123, v125, v125
    v_dot2c_f32_bf16 v120, s71, v126
    v_dot2c_f32_bf16 v122, v126, v126
    v_dot2c_f32_bf16 v121, s71, v127
    v_dot2c_f32_bf16 v123, v127, v127
    s_lshl_b32 s20, s73, 2
    s_mul_i32 s20, s20, 112
    s_lshl_b32 s21, s74, 3
    s_add_u32 s20, s20, s21
    s_lshl_b32 s21, s64, 1
    s_add_u32 s20, s20, s21
    s_lshl_b32 s20, s20, 10
    s_add_u32 s20, s20, 6291456
    s_lshl_b32 s34, s76, 2
    s_add_u32 s34, s34, s64
    s_mul_i32 s34, s34, 57344
    s_add_u32 s34, s34, 18350080
    s_lshl_b32 s21, s64, 8
    s_add_u32 s22, s20, 0
    ds_read_b64_tr_b16 v[92:93], v3 offset:12288
    s_waitcnt lgkmcnt(5)
    v_mfma_f32_32x32x16_bf16 v[48:63], a[0:3], v[80:83], 0
    ds_read_b64_tr_b16 v[94:95], v3 offset:13312
    v_add_f32 v120, v120, v121
    v_add_f32 v122, v122, v123
    v_mov_b32 v121, v120
    v_mov_b32 v123, v122
    v_mfma_f32_32x32x16_bf16 v[64:79], a[4:7], v[80:83], 0
    v_and_b32 v124, 31, v1
    v_permlane32_swap_b32 v120, v121
    v_permlane32_swap_b32 v122, v123
    v_lshlrev_b32 v124, 3, v124
    ds_read_b64_tr_b16 v[80:81], v3 offset:16384
    s_waitcnt lgkmcnt(5)
    v_mfma_f32_32x32x16_bf16 v[48:63], a[8:11], v[84:87], v[48:63]
    ds_read_b64_tr_b16 v[82:83], v3 offset:17408
    v_add_f32 v120, v120, v121
    v_add_f32 v122, v122, v123
    v_mul_f32 v120, 0x3b124925, v120
    v_mul_f32 v122, 0x3b124925, v122
    v_mfma_f32_32x32x16_bf16 v[64:79], a[12:15], v[84:87], v[64:79]
    v_add_u32 v123, 114688, v124
    v_fma_f32 v122, -v120, v120, v122
    v_max_f32 v122, 0, v122
    v_add_f32 v122, 0x3727c5ac, v122
    ds_read_b64_tr_b16 v[84:85], v3 offset:20480
    s_waitcnt lgkmcnt(5)
    v_mfma_f32_32x32x16_bf16 v[48:63], a[16:19], v[88:91], v[48:63]
    ds_read_b64_tr_b16 v[86:87], v3 offset:21504
    v_rsq_f32 v121, v122
    v_add_u32 v122, s21, v123
    ds_write_b64 v122, v[120:121]
    s_add_u32 s27, s34, 0
    buffer_load_dwordx4 v[140:143], v11, s[8:11], s27 offen offset:0 sc1
    v_mfma_f32_32x32x16_bf16 v[64:79], a[20:23], v[88:91], v[64:79]
    ds_read_b64_tr_b16 v[88:89], v3 offset:24576
    s_waitcnt lgkmcnt(6)
    v_mfma_f32_32x32x16_bf16 v[48:63], a[24:27], v[92:95], v[48:63]
    ds_read_b64_tr_b16 v[90:91], v3 offset:25600
    buffer_load_dwordx4 v[144:147], v11, s[8:11], s27 offen offset:1024 sc1
    v_mfma_f32_32x32x16_bf16 v[64:79], a[28:31], v[92:95], v[64:79]
    s_waitcnt lgkmcnt(2)
    s_barrier
    ds_read_b64 v[112:113], v123 offset:0
    ds_read_b64 v[114:115], v123 offset:256
    ds_read_b64 v[116:117], v123 offset:512
    ds_read_b64 v[118:119], v123 offset:768
    ds_read_b64_tr_b16 v[92:93], v3 offset:28672
    s_waitcnt lgkmcnt(10)
    v_mfma_f32_32x32x16_bf16 v[48:63], a[32:35], v[80:83], v[48:63]
    ds_read_b64_tr_b16 v[94:95], v3 offset:29696
    v_mfma_f32_32x32x16_bf16 v[64:79], a[36:39], v[80:83], v[64:79]
    ds_read_b64_tr_b16 v[80:81], v3 offset:32768
    s_waitcnt lgkmcnt(10)
    v_mfma_f32_32x32x16_bf16 v[48:63], a[40:43], v[84:87], v[48:63]
    ds_read_b64_tr_b16 v[82:83], v3 offset:33792
    buffer_load_dwordx4 v[148:151], v11, s[8:11], s27 offen offset:2048 sc1
    v_mfma_f32_32x32x16_bf16 v[64:79], a[44:47], v[84:87], v[64:79]
    ds_read_b64_tr_b16 v[84:85], v3 offset:36864
    s_waitcnt lgkmcnt(5)
    v_mfma_f32_32x32x16_bf16 v[48:63], a[48:51], v[88:91], v[48:63]
    ds_read_b64_tr_b16 v[86:87], v3 offset:37888
    v_cvt_pk_bf16_f32 v200, -v112, -v112
    v_lshlrev_b32 v204, 16, v200
    v_sub_f32_e64 v204, -v112, v204
    v_cvt_pk_bf16_f32 v201, v204, 0
    v_mfma_f32_32x32x16_bf16 v[64:79], a[52:55], v[88:91], v[64:79]
    buffer_load_dwordx4 v[152:155], v11, s[8:11], s27 offen offset:3072 sc1
    ds_read_b64_tr_b16 v[88:89], v3 offset:40960
    s_waitcnt lgkmcnt(5)
    v_mfma_f32_32x32x16_bf16 v[48:63], a[56:59], v[92:95], v[48:63]
    ds_read_b64_tr_b16 v[90:91], v3 offset:41984
    v_mfma_f32_32x32x16_bf16 v[16:31], v[192:195], v[200:203], v[16:31]
    v_mfma_f32_32x32x16_bf16 v[64:79], a[60:63], v[92:95], v[64:79]
    v_mfma_f32_32x32x16_bf16 v[32:47], v[196:199], v[200:203], v[32:47]
    ds_read_b64_tr_b16 v[92:93], v3 offset:45056
    s_waitcnt lgkmcnt(5)
    v_mfma_f32_32x32x16_bf16 v[48:63], a[64:67], v[80:83], v[48:63]
    ds_read_b64_tr_b16 v[94:95], v3 offset:46080
    s_add_u32 s27, s34, 4096
    buffer_load_dwordx4 v[156:159], v11, s[8:11], s27 offen offset:0 sc1
    v_mfma_f32_32x32x16_bf16 v[64:79], a[68:71], v[80:83], v[64:79]
    ds_read_b64_tr_b16 v[80:81], v3 offset:49152
    s_waitcnt lgkmcnt(5)
    v_mfma_f32_32x32x16_bf16 v[48:63], a[72:75], v[84:87], v[48:63]
    ds_read_b64_tr_b16 v[82:83], v3 offset:50176
    v_mul_f32 v124, 0xbfb8aa3b, v113
    v_mul_f32 v125, v113, v113
    v_rcp_f32 v125, v125
    v_mul_f32 v126, v124, v16
    v_mfma_f32_32x32x16_bf16 v[64:79], a[76:79], v[84:87], v[64:79]
    v_mul_f32 v127, v124, v17
    v_mul_f32 v128, v124, v18
    v_mul_f32 v129, v124, v19
    ds_read_b64_tr_b16 v[84:85], v3 offset:53248
    s_waitcnt lgkmcnt(5)
    v_mfma_f32_32x32x16_bf16 v[48:63], a[80:83], v[88:91], v[48:63]
    ds_read_b64_tr_b16 v[86:87], v3 offset:54272
    buffer_load_dwordx4 v[160:163], v11, s[8:11], s27 offen offset:1024 sc1
    v_exp_f32 v126, v126
    v_mul_f32 v16, v16, v32
    v_mfma_f32_32x32x16_bf16 v[64:79], a[84:87], v[88:91], v[64:79]
    v_exp_f32 v127, v127
    v_mul_f32 v17, v17, v33
    ds_read_b64_tr_b16 v[88:89], v3 offset:57344
    s_waitcnt lgkmcnt(5)
    v_mfma_f32_32x32x16_bf16 v[48:63], a[88:91], v[92:95], v[48:63]
    ds_read_b64_tr_b16 v[90:91], v3 offset:58368
    buffer_load_dwordx4 v[164:167], v11, s[8:11], s27 offen offset:2048 sc1
    v_exp_f32 v128, v128
    v_mul_f32 v18, v18, v34
    v_mfma_f32_32x32x16_bf16 v[64:79], a[92:95], v[92:95], v[64:79]
    v_exp_f32 v129, v129
    v_mul_f32 v19, v19, v35
    v_fma_f32 v126, v126, v125, v125
    ds_read_b64_tr_b16 v[92:93], v3 offset:61440
    s_waitcnt lgkmcnt(5)
    v_mfma_f32_32x32x16_bf16 v[48:63], a[96:99], v[80:83], v[48:63]
    ds_read_b64_tr_b16 v[94:95], v3 offset:62464
    v_fma_f32 v127, v127, v125, v125
    v_fma_f32 v128, v128, v125, v125
    v_fma_f32 v129, v129, v125, v125
    v_rcp_f32 v126, v126
    v_mfma_f32_32x32x16_bf16 v[64:79], a[100:103], v[80:83], v[64:79]
    v_rcp_f32 v127, v127
    v_rcp_f32 v128, v128
    ds_read_b64_tr_b16 v[80:81], v7 offset:0
    s_waitcnt lgkmcnt(5)
    v_mfma_f32_32x32x16_bf16 v[48:63], a[104:107], v[84:87], v[48:63]
    ds_read_b64_tr_b16 v[82:83], v7 offset:1024
    buffer_load_dwordx4 v[168:171], v11, s[8:11], s27 offen offset:3072 sc1
    v_rcp_f32 v129, v129
    v_mul_f32 v16, v16, v126
    v_mfma_f32_32x32x16_bf16 v[64:79], a[108:111], v[84:87], v[64:79]
    v_mul_f32 v17, v17, v127
    v_mul_f32 v18, v18, v128
    v_mul_f32 v19, v19, v129
    v_cvt_pk_bf16_f32 v132, v16, v17
    ds_read_b64_tr_b16 v[84:85], v7 offset:4096
    s_waitcnt lgkmcnt(5)
    v_mfma_f32_32x32x16_bf16 v[48:63], a[112:115], v[88:91], v[48:63]
    ds_read_b64_tr_b16 v[86:87], v7 offset:5120
    s_add_u32 s27, s34, 8192
    buffer_load_dwordx4 v[172:175], v11, s[8:11], s27 offen offset:0 sc1
    v_cvt_pk_bf16_f32 v133, v18, v19
    v_mul_f32 v126, v124, v20
    v_mfma_f32_32x32x16_bf16 v[64:79], a[116:119], v[88:91], v[64:79]
    v_mul_f32 v127, v124, v21
    v_mul_f32 v128, v124, v22
    v_mul_f32 v129, v124, v23
    ds_read_b64_tr_b16 v[88:89], v7 offset:8192
    s_waitcnt lgkmcnt(5)
    v_mfma_f32_32x32x16_bf16 v[48:63], a[120:123], v[92:95], v[48:63]
    ds_read_b64_tr_b16 v[90:91], v7 offset:9216
    v_exp_f32 v126, v126
    v_mul_f32 v20, v20, v36
    v_exp_f32 v127, v127
    v_mfma_f32_32x32x16_bf16 v[64:79], a[124:127], v[92:95], v[64:79]
    v_mul_f32 v21, v21, v37
    v_exp_f32 v128, v128
    v_mul_f32 v22, v22, v38
    ds_read_b64_tr_b16 v[92:93], v7 offset:12288
    s_waitcnt lgkmcnt(5)
    v_mfma_f32_32x32x16_bf16 v[48:63], a[128:131], v[80:83], v[48:63]
    ds_read_b64_tr_b16 v[94:95], v7 offset:13312
    buffer_load_dwordx4 v[176:179], v11, s[8:11], s27 offen offset:1024 sc1
    v_exp_f32 v129, v129
    v_mul_f32 v23, v23, v39
    v_mfma_f32_32x32x16_bf16 v[64:79], a[132:135], v[80:83], v[64:79]
    v_fma_f32 v126, v126, v125, v125
    v_fma_f32 v127, v127, v125, v125
    v_fma_f32 v128, v128, v125, v125
    v_fma_f32 v129, v129, v125, v125
    ds_read_b64_tr_b16 v[80:81], v7 offset:16384
    s_waitcnt lgkmcnt(5)
    v_mfma_f32_32x32x16_bf16 v[48:63], a[136:139], v[84:87], v[48:63]
    ds_read_b64_tr_b16 v[82:83], v7 offset:17408
    v_rcp_f32 v126, v126
    v_rcp_f32 v127, v127
    v_mfma_f32_32x32x16_bf16 v[64:79], a[140:143], v[84:87], v[64:79]
    v_rcp_f32 v128, v128
    v_rcp_f32 v129, v129
    ds_read_b64_tr_b16 v[84:85], v7 offset:20480
    s_waitcnt lgkmcnt(5)
    v_mfma_f32_32x32x16_bf16 v[48:63], a[144:147], v[88:91], v[48:63]
    ds_read_b64_tr_b16 v[86:87], v7 offset:21504
    buffer_load_dwordx4 v[180:183], v11, s[8:11], s27 offen offset:2048 sc1
    v_mul_f32 v20, v20, v126
    v_mul_f32 v21, v21, v127
    v_mul_f32 v22, v22, v128
    v_mfma_f32_32x32x16_bf16 v[64:79], a[148:151], v[88:91], v[64:79]
    v_mul_f32 v23, v23, v129
    v_cvt_pk_bf16_f32 v134, v20, v21
    v_cvt_pk_bf16_f32 v135, v22, v23
    ds_read_b64_tr_b16 v[88:89], v7 offset:24576
    s_waitcnt lgkmcnt(5)
    v_mfma_f32_32x32x16_bf16 v[48:63], a[152:155], v[92:95], v[48:63]
    ds_read_b64_tr_b16 v[90:91], v7 offset:25600
    buffer_load_dwordx4 v[184:187], v11, s[8:11], s27 offen offset:3072 sc1
    buffer_store_dwordx4 v[132:135], v11, s[8:11], s22 offen offset:0 sc1
    v_mul_f32 v126, v124, v24
    v_mfma_f32_32x32x16_bf16 v[64:79], a[156:159], v[92:95], v[64:79]
    v_mul_f32 v127, v124, v25
    v_mul_f32 v128, v124, v26
    v_mul_f32 v129, v124, v27
    ds_read_b64_tr_b16 v[92:93], v7 offset:28672
    s_waitcnt lgkmcnt(5)
    v_mfma_f32_32x32x16_bf16 v[48:63], a[160:163], v[80:83], v[48:63]
    ds_read_b64_tr_b16 v[94:95], v7 offset:29696
    v_exp_f32 v126, v126
    v_mul_f32 v24, v24, v40
    v_exp_f32 v127, v127
    v_mfma_f32_32x32x16_bf16 v[64:79], a[164:167], v[80:83], v[64:79]
    v_mul_f32 v25, v25, v41
    v_exp_f32 v128, v128
    v_mul_f32 v26, v26, v42
    ds_read_b64_tr_b16 v[80:81], v7 offset:32768
    s_waitcnt lgkmcnt(5)
    v_mfma_f32_32x32x16_bf16 v[48:63], a[168:171], v[84:87], v[48:63]
    ds_read_b64_tr_b16 v[82:83], v7 offset:33792
    s_add_u32 s27, s34, 12288
    buffer_load_dwordx4 v[188:191], v11, s[8:11], s27 offen offset:0 sc1
    v_exp_f32 v129, v129
    v_mfma_f32_32x32x16_bf16 v[64:79], a[172:175], v[84:87], v[64:79]
    v_mul_f32 v27, v27, v43
    v_fma_f32 v126, v126, v125, v125
    v_fma_f32 v127, v127, v125, v125
    v_fma_f32 v128, v128, v125, v125
    ds_read_b64_tr_b16 v[84:85], v7 offset:36864
    s_waitcnt lgkmcnt(5)
    v_mfma_f32_32x32x16_bf16 v[48:63], a[176:179], v[88:91], v[48:63]
    ds_read_b64_tr_b16 v[86:87], v7 offset:37888
    v_fma_f32 v129, v129, v125, v125
    v_rcp_f32 v126, v126
    v_rcp_f32 v127, v127
    v_mfma_f32_32x32x16_bf16 v[64:79], a[180:183], v[88:91], v[64:79]
    v_rcp_f32 v128, v128
    v_rcp_f32 v129, v129
    ds_read_b64_tr_b16 v[88:89], v7 offset:40960
    s_waitcnt lgkmcnt(5)
    v_mfma_f32_32x32x16_bf16 v[48:63], a[184:187], v[92:95], v[48:63]
    ds_read_b64_tr_b16 v[90:91], v7 offset:41984
    buffer_load_dwordx4 v[224:227], v11, s[8:11], s27 offen offset:1024 sc1
    v_mul_f32 v24, v24, v126
    v_mul_f32 v25, v25, v127
    v_mul_f32 v26, v26, v128
    v_mfma_f32_32x32x16_bf16 v[64:79], a[188:191], v[92:95], v[64:79]
    v_mul_f32 v27, v27, v129
    v_cvt_pk_bf16_f32 v136, v24, v25
    v_cvt_pk_bf16_f32 v137, v26, v27
    v_mul_f32 v126, v124, v28
    ds_read_b64_tr_b16 v[92:93], v7 offset:45056
    s_waitcnt lgkmcnt(5)
    v_mfma_f32_32x32x16_bf16 v[48:63], a[192:195], v[80:83], v[48:63]
    ds_read_b64_tr_b16 v[94:95], v7 offset:46080
    buffer_load_dwordx4 v[228:231], v11, s[8:11], s27 offen offset:2048 sc1
    v_mul_f32 v127, v124, v29
    v_mul_f32 v128, v124, v30
    v_mul_f32 v129, v124, v31
    v_mfma_f32_32x32x16_bf16 v[64:79], a[196:199], v[80:83], v[64:79]
    v_exp_f32 v126, v126
    v_mul_f32 v28, v28, v44
    ds_read_b64_tr_b16 v[80:81], v4 offset:0
    s_waitcnt lgkmcnt(5)
    v_mfma_f32_32x32x16_bf16 v[48:63], a[200:203], v[84:87], v[48:63]
    ds_read_b64_tr_b16 v[82:83], v4 offset:1024
    v_exp_f32 v127, v127
    v_mul_f32 v29, v29, v45
    v_exp_f32 v128, v128
    v_mfma_f32_32x32x16_bf16 v[64:79], a[204:207], v[84:87], v[64:79]
    v_mul_f32 v30, v30, v46
    v_exp_f32 v129, v129
    v_mul_f32 v31, v31, v47
    ds_read_b64_tr_b16 v[84:85], v4 offset:4096
    s_waitcnt lgkmcnt(5)
    v_mfma_f32_32x32x16_bf16 v[48:63], a[208:211], v[88:91], v[48:63]
    ds_read_b64_tr_b16 v[86:87], v4 offset:5120
    buffer_load_dwordx4 v[232:235], v11, s[8:11], s27 offen offset:3072 sc1
    v_fma_f32 v126, v126, v125, v125
    v_fma_f32 v127, v127, v125, v125
    v_fma_f32 v128, v128, v125, v125
    v_mfma_f32_32x32x16_bf16 v[64:79], a[212:215], v[88:91], v[64:79]
    v_fma_f32 v129, v129, v125, v125
    v_rcp_f32 v126, v126
    ds_read_b64_tr_b16 v[88:89], v4 offset:8192
    s_waitcnt lgkmcnt(5)
    v_mfma_f32_32x32x16_bf16 v[48:63], a[216:219], v[92:95], v[48:63]
    ds_read_b64_tr_b16 v[90:91], v4 offset:9216
    s_add_u32 s27, s34, 16384
    buffer_load_dwordx4 v[236:239], v11, s[8:11], s27 offen offset:0 sc1
    v_rcp_f32 v127, v127
    v_mfma_f32_32x32x16_bf16 v[64:79], a[220:223], v[92:95], v[64:79]
    v_rcp_f32 v128, v128
    v_rcp_f32 v129, v129
    v_mul_f32 v28, v28, v126
    v_mul_f32 v29, v29, v127
    v_mul_f32 v30, v30, v128
    v_mul_f32 v31, v31, v129
    v_cvt_pk_bf16_f32 v138, v28, v29
    v_cvt_pk_bf16_f32 v139, v30, v31
    buffer_store_dwordx4 v[136:139], v11, s[8:11], s22 offen offset:1024 sc1
    s_add_u32 s22, s20, 114688
    ds_read_b64_tr_b16 v[92:93], v4 offset:12288
    s_waitcnt lgkmcnt(5)
    v_mfma_f32_32x32x16_bf16 v[16:31], a[0:3], v[80:83], 0
    ds_read_b64_tr_b16 v[94:95], v4 offset:13312
    v_mfma_f32_32x32x16_bf16 v[32:47], a[4:7], v[80:83], 0
    ds_read_b64_tr_b16 v[80:81], v4 offset:16384
    s_waitcnt lgkmcnt(5)
    v_mfma_f32_32x32x16_bf16 v[16:31], a[8:11], v[84:87], v[16:31]
    ds_read_b64_tr_b16 v[82:83], v4 offset:17408
    v_cvt_pk_bf16_f32 v200, -v114, -v114
    v_lshlrev_b32 v204, 16, v200
    v_sub_f32_e64 v204, -v114, v204
    v_cvt_pk_bf16_f32 v201, v204, 0
    v_mfma_f32_32x32x16_bf16 v[32:47], a[12:15], v[84:87], v[32:47]
    buffer_load_dwordx4 v[240:243], v11, s[8:11], s27 offen offset:1024 sc1
    ds_read_b64_tr_b16 v[84:85], v4 offset:20480
    s_waitcnt lgkmcnt(5)
    v_mfma_f32_32x32x16_bf16 v[16:31], a[16:19], v[88:91], v[16:31]
    ds_read_b64_tr_b16 v[86:87], v4 offset:21504
    v_mfma_f32_32x32x16_bf16 v[48:63], v[192:195], v[200:203], v[48:63]
    v_mfma_f32_32x32x16_bf16 v[32:47], a[20:23], v[88:91], v[32:47]
    v_mfma_f32_32x32x16_bf16 v[64:79], v[196:199], v[200:203], v[64:79]
    ds_read_b64_tr_b16 v[88:89], v4 offset:24576
    s_waitcnt lgkmcnt(5)
    v_mfma_f32_32x32x16_bf16 v[16:31], a[24:27], v[92:95], v[16:31]
    ds_read_b64_tr_b16 v[90:91], v4 offset:25600
    buffer_load_dwordx4 v[244:247], v11, s[8:11], s27 offen offset:2048 sc1
    v_mfma_f32_32x32x16_bf16 v[32:47], a[28:31], v[92:95], v[32:47]
    ds_read_b64_tr_b16 v[92:93], v4 offset:28672
    s_waitcnt lgkmcnt(5)
    v_mfma_f32_32x32x16_bf16 v[16:31], a[32:35], v[80:83], v[16:31]
    ds_read_b64_tr_b16 v[94:95], v4 offset:29696
    buffer_load_dwordx4 v[248:251], v11, s[8:11], s27 offen offset:3072 sc1
    v_mul_f32 v124, 0xbfb8aa3b, v115
    v_mul_f32 v125, v115, v115
    v_mfma_f32_32x32x16_bf16 v[32:47], a[36:39], v[80:83], v[32:47]
    v_rcp_f32 v125, v125
    v_mul_f32 v126, v124, v48
    v_mul_f32 v127, v124, v49
    ds_read_b64_tr_b16 v[80:81], v4 offset:32768
    s_waitcnt lgkmcnt(5)
    v_mfma_f32_32x32x16_bf16 v[16:31], a[40:43], v[84:87], v[16:31]
    ds_read_b64_tr_b16 v[82:83], v4 offset:33792
    v_mul_f32 v128, v124, v50
    v_mul_f32 v129, v124, v51
    v_exp_f32 v126, v126
    v_mul_f32 v48, v48, v64
    v_mfma_f32_32x32x16_bf16 v[32:47], a[44:47], v[84:87], v[32:47]
    v_exp_f32 v127, v127
    v_mul_f32 v49, v49, v65
    ds_read_b64_tr_b16 v[84:85], v4 offset:36864
    s_waitcnt lgkmcnt(5)
    v_mfma_f32_32x32x16_bf16 v[16:31], a[48:51], v[88:91], v[16:31]
    ds_read_b64_tr_b16 v[86:87], v4 offset:37888
    s_add_u32 s27, s34, 20480
    buffer_load_dwordx4 v[252:255], v11, s[8:11], s27 offen offset:0 sc1
    v_exp_f32 v128, v128
    v_mfma_f32_32x32x16_bf16 v[32:47], a[52:55], v[88:91], v[32:47]
    v_mul_f32 v50, v50, v66
    v_exp_f32 v129, v129
    v_mul_f32 v51, v51, v67
    ds_read_b64_tr_b16 v[88:89], v4 offset:40960
    s_waitcnt lgkmcnt(5)
    v_mfma_f32_32x32x16_bf16 v[16:31], a[56:59], v[92:95], v[16:31]
    ds_read_b64_tr_b16 v[90:91], v4 offset:41984
    v_fma_f32 v126, v126, v125, v125
    v_fma_f32 v127, v127, v125, v125
    v_fma_f32 v128, v128, v125, v125
    v_fma_f32 v129, v129, v125, v125
    v_mfma_f32_32x32x16_bf16 v[32:47], a[60:63], v[92:95], v[32:47]
    v_rcp_f32 v126, v126
    v_rcp_f32 v127, v127
    ds_read_b64_tr_b16 v[92:93], v4 offset:45056
    s_waitcnt lgkmcnt(5)
    v_mfma_f32_32x32x16_bf16 v[16:31], a[64:67], v[80:83], v[16:31]
    ds_read_b64_tr_b16 v[94:95], v4 offset:46080
    buffer_load_dwordx4 a[224:227], v11, s[8:11], s27 offen offset:1024 sc1
    v_rcp_f32 v128, v128
    v_mfma_f32_32x32x16_bf16 v[32:47], a[68:71], v[80:83], v[32:47]
    v_rcp_f32 v129, v129
    v_mul_f32 v48, v48, v126
    v_mul_f32 v49, v49, v127
    ds_read_b64_tr_b16 v[80:81], v4 offset:49152
    s_waitcnt lgkmcnt(5)
    v_mfma_f32_32x32x16_bf16 v[16:31], a[72:75], v[84:87], v[16:31]
    ds_read_b64_tr_b16 v[82:83], v4 offset:50176
    buffer_load_dwordx4 a[228:231], v11, s[8:11], s27 offen offset:2048 sc1
    v_mul_f32 v50, v50, v128
    v_mul_f32 v51, v51, v129
    v_cvt_pk_bf16_f32 v132, v48, v49
    v_mfma_f32_32x32x16_bf16 v[32:47], a[76:79], v[84:87], v[32:47]
    v_cvt_pk_bf16_f32 v133, v50, v51
    v_mul_f32 v126, v124, v52
    v_mul_f32 v127, v124, v53
    v_mul_f32 v128, v124, v54
    ds_read_b64_tr_b16 v[84:85], v4 offset:53248
    s_waitcnt lgkmcnt(5)
    v_mfma_f32_32x32x16_bf16 v[16:31], a[80:83], v[88:91], v[16:31]
    ds_read_b64_tr_b16 v[86:87], v4 offset:54272
    v_mul_f32 v129, v124, v55
    v_exp_f32 v126, v126
    v_mul_f32 v52, v52, v68
    v_mfma_f32_32x32x16_bf16 v[32:47], a[84:87], v[88:91], v[32:47]
    v_exp_f32 v127, v127
    v_mul_f32 v53, v53, v69
    ds_read_b64_tr_b16 v[88:89], v4 offset:57344
    s_waitcnt lgkmcnt(5)
    v_mfma_f32_32x32x16_bf16 v[16:31], a[88:91], v[92:95], v[16:31]
    ds_read_b64_tr_b16 v[90:91], v4 offset:58368
    buffer_load_dwordx4 a[232:235], v11, s[8:11], s27 offen offset:3072 sc1
    v_exp_f32 v128, v128
    v_mul_f32 v54, v54, v70
    v_mfma_f32_32x32x16_bf16 v[32:47], a[92:95], v[92:95], v[32:47]
    v_exp_f32 v129, v129
    v_mul_f32 v55, v55, v71
    v_fma_f32 v126, v126, v125, v125
    ds_read_b64_tr_b16 v[92:93], v4 offset:61440
    s_waitcnt lgkmcnt(5)
    v_mfma_f32_32x32x16_bf16 v[16:31], a[96:99], v[80:83], v[16:31]
    ds_read_b64_tr_b16 v[94:95], v4 offset:62464
    s_add_u32 s27, s34, 24576
    buffer_load_dwordx4 a[236:239], v11, s[8:11], s27 offen offset:0 sc1
    v_fma_f32 v127, v127, v125, v125
    v_fma_f32 v128, v128, v125, v125
    v_mfma_f32_32x32x16_bf16 v[32:47], a[100:103], v[80:83], v[32:47]
    v_fma_f32 v129, v129, v125, v125
    v_rcp_f32 v126, v126
    ds_read_b64_tr_b16 v[80:81], v8 offset:0
    s_waitcnt lgkmcnt(5)
    v_mfma_f32_32x32x16_bf16 v[16:31], a[104:107], v[84:87], v[16:31]
    ds_read_b64_tr_b16 v[82:83], v8 offset:1024
    v_rcp_f32 v127, v127
    v_rcp_f32 v128, v128
    v_mfma_f32_32x32x16_bf16 v[32:47], a[108:111], v[84:87], v[32:47]
    v_rcp_f32 v129, v129
    v_mul_f32 v52, v52, v126
    v_mul_f32 v53, v53, v127
    ds_read_b64_tr_b16 v[84:85], v8 offset:4096
    s_waitcnt lgkmcnt(5)
    v_mfma_f32_32x32x16_bf16 v[16:31], a[112:115], v[88:91], v[16:31]
    ds_read_b64_tr_b16 v[86:87], v8 offset:5120
    buffer_load_dwordx4 a[240:243], v11, s[8:11], s27 offen offset:1024 sc1
    v_mul_f32 v54, v54, v128
    v_mul_f32 v55, v55, v129
    v_cvt_pk_bf16_f32 v134, v52, v53
    v_mfma_f32_32x32x16_bf16 v[32:47], a[116:119], v[88:91], v[32:47]
    v_cvt_pk_bf16_f32 v135, v54, v55
    buffer_store_dwordx4 v[132:135], v11, s[8:11], s22 offen offset:0 sc1
    v_mul_f32 v126, v124, v56
    ds_read_b64_tr_b16 v[88:89], v8 offset:8192
    s_waitcnt lgkmcnt(5)
    v_mfma_f32_32x32x16_bf16 v[16:31], a[120:123], v[92:95], v[16:31]
    ds_read_b64_tr_b16 v[90:91], v8 offset:9216
    v_mul_f32 v127, v124, v57
    v_mul_f32 v128, v124, v58
    v_mul_f32 v129, v124, v59
    v_exp_f32 v126, v126
    v_mfma_f32_32x32x16_bf16 v[32:47], a[124:127], v[92:95], v[32:47]
    v_mul_f32 v56, v56, v72
    v_exp_f32 v127, v127
    v_mul_f32 v57, v57, v73
    ds_read_b64_tr_b16 v[92:93], v8 offset:12288
    s_waitcnt lgkmcnt(5)
    v_mfma_f32_32x32x16_bf16 v[16:31], a[128:131], v[80:83], v[16:31]
    ds_read_b64_tr_b16 v[94:95], v8 offset:13312
    buffer_load_dwordx4 a[244:247], v11, s[8:11], s27 offen offset:2048 sc1
    v_exp_f32 v128, v128
    v_mul_f32 v58, v58, v74
    v_mfma_f32_32x32x16_bf16 v[32:47], a[132:135], v[80:83], v[32:47]
    v_exp_f32 v129, v129
    v_mul_f32 v59, v59, v75
    v_fma_f32 v126, v126, v125, v125
    ds_read_b64_tr_b16 v[80:81], v8 offset:16384
    s_waitcnt lgkmcnt(5)
    v_mfma_f32_32x32x16_bf16 v[16:31], a[136:139], v[84:87], v[16:31]
    ds_read_b64_tr_b16 v[82:83], v8 offset:17408
    buffer_load_dwordx4 a[248:251], v11, s[8:11], s27 offen offset:3072 sc1
    v_fma_f32 v127, v127, v125, v125
    v_fma_f32 v128, v128, v125, v125
    v_fma_f32 v129, v129, v125, v125
    v_mfma_f32_32x32x16_bf16 v[32:47], a[140:143], v[84:87], v[32:47]
    v_rcp_f32 v126, v126
    v_rcp_f32 v127, v127
    ds_read_b64_tr_b16 v[84:85], v8 offset:20480
    s_waitcnt lgkmcnt(5)
    v_mfma_f32_32x32x16_bf16 v[16:31], a[144:147], v[88:91], v[16:31]
    ds_read_b64_tr_b16 v[86:87], v8 offset:21504
    v_rcp_f32 v128, v128
    v_rcp_f32 v129, v129
    v_mul_f32 v56, v56, v126
    v_mfma_f32_32x32x16_bf16 v[32:47], a[148:151], v[88:91], v[32:47]
    v_mul_f32 v57, v57, v127
    v_mul_f32 v58, v58, v128
    v_mul_f32 v59, v59, v129
    v_cvt_pk_bf16_f32 v136, v56, v57
    ds_read_b64_tr_b16 v[88:89], v8 offset:24576
    s_waitcnt lgkmcnt(5)
    v_mfma_f32_32x32x16_bf16 v[16:31], a[152:155], v[92:95], v[16:31]
    ds_read_b64_tr_b16 v[90:91], v8 offset:25600
    s_add_u32 s27, s34, 28672
    buffer_load_dwordx4 a[252:255], v11, s[8:11], s27 offen offset:0 sc1
    v_cvt_pk_bf16_f32 v137, v58, v59
    v_mul_f32 v126, v124, v60
    v_mfma_f32_32x32x16_bf16 v[32:47], a[156:159], v[92:95], v[32:47]
    v_mul_f32 v127, v124, v61
    v_mul_f32 v128, v124, v62
    v_mul_f32 v129, v124, v63
    ds_read_b64_tr_b16 v[92:93], v8 offset:28672
    s_waitcnt lgkmcnt(5)
    v_mfma_f32_32x32x16_bf16 v[16:31], a[160:163], v[80:83], v[16:31]
    ds_read_b64_tr_b16 v[94:95], v8 offset:29696
    v_exp_f32 v126, v126
    v_mul_f32 v60, v60, v76
    v_exp_f32 v127, v127
    v_mfma_f32_32x32x16_bf16 v[32:47], a[164:167], v[80:83], v[32:47]
    v_mul_f32 v61, v61, v77
    v_exp_f32 v128, v128
    v_mul_f32 v62, v62, v78
    ds_read_b64_tr_b16 v[80:81], v8 offset:32768
    s_waitcnt lgkmcnt(5)
    v_mfma_f32_32x32x16_bf16 v[16:31], a[168:171], v[84:87], v[16:31]
    ds_read_b64_tr_b16 v[82:83], v8 offset:33792
    buffer_load_dwordx4 v[96:99], v11, s[8:11], s27 offen offset:1024 sc1
    v_exp_f32 v129, v129
    v_mul_f32 v63, v63, v79
    v_mfma_f32_32x32x16_bf16 v[32:47], a[172:175], v[84:87], v[32:47]
    v_fma_f32 v126, v126, v125, v125
    v_fma_f32 v127, v127, v125, v125
    v_fma_f32 v128, v128, v125, v125
    v_fma_f32 v129, v129, v125, v125
    ds_read_b64_tr_b16 v[84:85], v8 offset:36864
    s_waitcnt lgkmcnt(5)
    v_mfma_f32_32x32x16_bf16 v[16:31], a[176:179], v[88:91], v[16:31]
    ds_read_b64_tr_b16 v[86:87], v8 offset:37888
    buffer_load_dwordx4 v[100:103], v11, s[8:11], s27 offen offset:2048 sc1
    v_rcp_f32 v126, v126
    v_mfma_f32_32x32x16_bf16 v[32:47], a[180:183], v[88:91], v[32:47]
    v_rcp_f32 v127, v127
    v_rcp_f32 v128, v128
    ds_read_b64_tr_b16 v[88:89], v8 offset:40960
    s_waitcnt lgkmcnt(5)
    v_mfma_f32_32x32x16_bf16 v[16:31], a[184:187], v[92:95], v[16:31]
    ds_read_b64_tr_b16 v[90:91], v8 offset:41984
    v_rcp_f32 v129, v129
    v_mul_f32 v60, v60, v126
    v_mul_f32 v61, v61, v127
    v_mul_f32 v62, v62, v128
    v_mfma_f32_32x32x16_bf16 v[32:47], a[188:191], v[92:95], v[32:47]
    v_mul_f32 v63, v63, v129
    v_cvt_pk_bf16_f32 v138, v60, v61
    v_cvt_pk_bf16_f32 v139, v62, v63
    ds_read_b64_tr_b16 v[92:93], v8 offset:45056
    s_waitcnt lgkmcnt(5)
    v_mfma_f32_32x32x16_bf16 v[16:31], a[192:195], v[80:83], v[16:31]
    ds_read_b64_tr_b16 v[94:95], v8 offset:46080
    buffer_load_dwordx4 v[104:107], v11, s[8:11], s27 offen offset:3072 sc1
    buffer_store_dwordx4 v[136:139], v11, s[8:11], s22 offen offset:1024 sc1
    v_mfma_f32_32x32x16_bf16 v[32:47], a[196:199], v[80:83], v[32:47]
    ds_read_b64_tr_b16 v[80:81], v5 offset:0
    s_waitcnt lgkmcnt(5)
    v_mfma_f32_32x32x16_bf16 v[16:31], a[200:203], v[84:87], v[16:31]
    ds_read_b64_tr_b16 v[82:83], v5 offset:1024
    v_mfma_f32_32x32x16_bf16 v[32:47], a[204:207], v[84:87], v[32:47]
    ds_read_b64_tr_b16 v[84:85], v5 offset:4096
    s_waitcnt lgkmcnt(5)
    v_mfma_f32_32x32x16_bf16 v[16:31], a[208:211], v[88:91], v[16:31]
    ds_read_b64_tr_b16 v[86:87], v5 offset:5120
    v_mfma_f32_32x32x16_bf16 v[32:47], a[212:215], v[88:91], v[32:47]
    ds_read_b64_tr_b16 v[88:89], v5 offset:8192
    s_waitcnt lgkmcnt(5)
    v_mfma_f32_32x32x16_bf16 v[16:31], a[216:219], v[92:95], v[16:31]
    ds_read_b64_tr_b16 v[90:91], v5 offset:9216
    v_mfma_f32_32x32x16_bf16 v[32:47], a[220:223], v[92:95], v[32:47]
    s_add_u32 s22, s20, 229376
    ds_read_b64_tr_b16 v[92:93], v5 offset:12288
    s_waitcnt lgkmcnt(5)
    v_mfma_f32_32x32x16_bf16 v[48:63], a[0:3], v[80:83], 0
    ds_read_b64_tr_b16 v[94:95], v5 offset:13312
    v_mfma_f32_32x32x16_bf16 v[64:79], a[4:7], v[80:83], 0
    ds_read_b64_tr_b16 v[80:81], v5 offset:16384
    s_waitcnt lgkmcnt(5)
    v_mfma_f32_32x32x16_bf16 v[48:63], a[8:11], v[84:87], v[48:63]
    ds_read_b64_tr_b16 v[82:83], v5 offset:17408
    v_cvt_pk_bf16_f32 v200, -v116, -v116
    v_lshlrev_b32 v204, 16, v200
    v_sub_f32_e64 v204, -v116, v204
    v_cvt_pk_bf16_f32 v201, v204, 0
    v_mfma_f32_32x32x16_bf16 v[64:79], a[12:15], v[84:87], v[64:79]
    ds_read_b64_tr_b16 v[84:85], v5 offset:20480
    s_waitcnt lgkmcnt(5)
    v_mfma_f32_32x32x16_bf16 v[48:63], a[16:19], v[88:91], v[48:63]
    ds_read_b64_tr_b16 v[86:87], v5 offset:21504
    v_mfma_f32_32x32x16_bf16 v[16:31], v[192:195], v[200:203], v[16:31]
    s_add_u32 s27, s34, 32768
    buffer_load_dwordx4 a[0:3], v11, s[8:11], s27 offen offset:0 sc1
    v_mfma_f32_32x32x16_bf16 v[64:79], a[20:23], v[88:91], v[64:79]
    v_mfma_f32_32x32x16_bf16 v[32:47], v[196:199], v[200:203], v[32:47]
    ds_read_b64_tr_b16 v[88:89], v5 offset:24576
    s_waitcnt lgkmcnt(5)
    v_mfma_f32_32x32x16_bf16 v[48:63], a[24:27], v[92:95], v[48:63]
    ds_read_b64_tr_b16 v[90:91], v5 offset:25600
    buffer_load_dwordx4 a[4:7], v11, s[8:11], s27 offen offset:1024 sc1
    v_mfma_f32_32x32x16_bf16 v[64:79], a[28:31], v[92:95], v[64:79]
    ds_read_b64_tr_b16 v[92:93], v5 offset:28672
    s_waitcnt lgkmcnt(5)
    v_mfma_f32_32x32x16_bf16 v[48:63], a[32:35], v[80:83], v[48:63]
    ds_read_b64_tr_b16 v[94:95], v5 offset:29696
    buffer_load_dwordx4 a[8:11], v11, s[8:11], s27 offen offset:2048 sc1
    v_mul_f32 v124, 0xbfb8aa3b, v117
    v_mul_f32 v125, v117, v117
    v_mfma_f32_32x32x16_bf16 v[64:79], a[36:39], v[80:83], v[64:79]
    v_rcp_f32 v125, v125
    v_mul_f32 v126, v124, v16
    v_mul_f32 v127, v124, v17
    ds_read_b64_tr_b16 v[80:81], v5 offset:32768
    s_waitcnt lgkmcnt(5)
    v_mfma_f32_32x32x16_bf16 v[48:63], a[40:43], v[84:87], v[48:63]
    ds_read_b64_tr_b16 v[82:83], v5 offset:33792
    buffer_load_dwordx4 a[12:15], v11, s[8:11], s27 offen offset:3072 sc1
    v_mul_f32 v128, v124, v18
    v_mul_f32 v129, v124, v19
    v_mfma_f32_32x32x16_bf16 v[64:79], a[44:47], v[84:87], v[64:79]
    v_exp_f32 v126, v126
    v_mul_f32 v16, v16, v32
    ds_read_b64_tr_b16 v[84:85], v5 offset:36864
    s_waitcnt lgkmcnt(5)
    v_mfma_f32_32x32x16_bf16 v[48:63], a[48:51], v[88:91], v[48:63]
    ds_read_b64_tr_b16 v[86:87], v5 offset:37888
    s_add_u32 s27, s34, 36864
    buffer_load_dwordx4 a[16:19], v11, s[8:11], s27 offen offset:0 sc1
    v_exp_f32 v127, v127
    v_mfma_f32_32x32x16_bf16 v[64:79], a[52:55], v[88:91], v[64:79]
    v_mul_f32 v17, v17, v33
    v_exp_f32 v128, v128
    v_mul_f32 v18, v18, v34
    ds_read_b64_tr_b16 v[88:89], v5 offset:40960
    s_waitcnt lgkmcnt(5)
    v_mfma_f32_32x32x16_bf16 v[48:63], a[56:59], v[92:95], v[48:63]
    ds_read_b64_tr_b16 v[90:91], v5 offset:41984
    buffer_load_dwordx4 a[20:23], v11, s[8:11], s27 offen offset:1024 sc1
    v_exp_f32 v129, v129
    v_mul_f32 v19, v19, v35
    v_mfma_f32_32x32x16_bf16 v[64:79], a[60:63], v[92:95], v[64:79]
    v_fma_f32 v126, v126, v125, v125
    v_fma_f32 v127, v127, v125, v125
    v_fma_f32 v128, v128, v125, v125
    v_fma_f32 v129, v129, v125, v125
    ds_read_b64_tr_b16 v[92:93], v5 offset:45056
    s_waitcnt lgkmcnt(5)
    v_mfma_f32_32x32x16_bf16 v[48:63], a[64:67], v[80:83], v[48:63]
    ds_read_b64_tr_b16 v[94:95], v5 offset:46080
    buffer_load_dwordx4 a[24:27], v11, s[8:11], s27 offen offset:2048 sc1
    v_rcp_f32 v126, v126
    v_mfma_f32_32x32x16_bf16 v[64:79], a[68:71], v[80:83], v[64:79]
    v_rcp_f32 v127, v127
    v_rcp_f32 v128, v128
    ds_read_b64_tr_b16 v[80:81], v5 offset:49152
    s_waitcnt lgkmcnt(5)
    v_mfma_f32_32x32x16_bf16 v[48:63], a[72:75], v[84:87], v[48:63]
    ds_read_b64_tr_b16 v[82:83], v5 offset:50176
    buffer_load_dwordx4 a[28:31], v11, s[8:11], s27 offen offset:3072 sc1
    v_rcp_f32 v129, v129
    v_mul_f32 v16, v16, v126
    v_mfma_f32_32x32x16_bf16 v[64:79], a[76:79], v[84:87], v[64:79]
    v_mul_f32 v17, v17, v127
    v_mul_f32 v18, v18, v128
    v_mul_f32 v19, v19, v129
    v_cvt_pk_bf16_f32 v132, v16, v17
    ds_read_b64_tr_b16 v[84:85], v5 offset:53248
    s_waitcnt lgkmcnt(5)
    v_mfma_f32_32x32x16_bf16 v[48:63], a[80:83], v[88:91], v[48:63]
    ds_read_b64_tr_b16 v[86:87], v5 offset:54272
    s_add_u32 s27, s34, 40960
    buffer_load_dwordx4 a[32:35], v11, s[8:11], s27 offen offset:0 sc1
    v_cvt_pk_bf16_f32 v133, v18, v19
    v_mul_f32 v126, v124, v20
    v_mfma_f32_32x32x16_bf16 v[64:79], a[84:87], v[88:91], v[64:79]
    v_mul_f32 v127, v124, v21
    v_mul_f32 v128, v124, v22
    v_mul_f32 v129, v124, v23
    s_waitcnt vmcnt(9)
    s_lshl_b32 s21, s73, 8
    s_add_u32 s21, s21, 20592640
    s_mov_b64 exec, 1
    v_mov_b32 v130, 0
    v_mov_b32 v131, 1
    buffer_atomic_add v131, v130, s[8:11], s21 offen
    s_mov_b64 exec, -1
    ds_read_b64_tr_b16 v[88:89], v5 offset:57344
    s_waitcnt lgkmcnt(5)
    v_mfma_f32_32x32x16_bf16 v[48:63], a[88:91], v[92:95], v[48:63]
    ds_read_b64_tr_b16 v[90:91], v5 offset:58368
    buffer_load_dwordx4 a[36:39], v11, s[8:11], s27 offen offset:1024 sc1
    v_exp_f32 v126, v126
    v_mul_f32 v20, v20, v36
    v_mfma_f32_32x32x16_bf16 v[64:79], a[92:95], v[92:95], v[64:79]
    v_exp_f32 v127, v127
    v_mul_f32 v21, v21, v37
    ds_read_b64_tr_b16 v[92:93], v5 offset:61440
    s_waitcnt lgkmcnt(5)
    v_mfma_f32_32x32x16_bf16 v[48:63], a[96:99], v[80:83], v[48:63]
    ds_read_b64_tr_b16 v[94:95], v5 offset:62464
    buffer_load_dwordx4 a[40:43], v11, s[8:11], s27 offen offset:2048 sc1
    v_exp_f32 v128, v128
    v_mul_f32 v22, v22, v38
    v_mfma_f32_32x32x16_bf16 v[64:79], a[100:103], v[80:83], v[64:79]
    v_exp_f32 v129, v129
    v_mul_f32 v23, v23, v39
    v_fma_f32 v126, v126, v125, v125
    ds_read_b64_tr_b16 v[80:81], v9 offset:0
    s_waitcnt lgkmcnt(5)
    v_mfma_f32_32x32x16_bf16 v[48:63], a[104:107], v[84:87], v[48:63]
    ds_read_b64_tr_b16 v[82:83], v9 offset:1024
    buffer_load_dwordx4 a[44:47], v11, s[8:11], s27 offen offset:3072 sc1
    v_fma_f32 v127, v127, v125, v125
    v_fma_f32 v128, v128, v125, v125
    v_fma_f32 v129, v129, v125, v125
    v_mfma_f32_32x32x16_bf16 v[64:79], a[108:111], v[84:87], v[64:79]
    v_rcp_f32 v126, v126
    v_rcp_f32 v127, v127
    ds_read_b64_tr_b16 v[84:85], v9 offset:4096
    s_waitcnt lgkmcnt(5)
    v_mfma_f32_32x32x16_bf16 v[48:63], a[112:115], v[88:91], v[48:63]
    ds_read_b64_tr_b16 v[86:87], v9 offset:5120
    s_add_u32 s27, s34, 45056
    buffer_load_dwordx4 a[48:51], v11, s[8:11], s27 offen offset:0 sc1
    v_rcp_f32 v128, v128
    v_mfma_f32_32x32x16_bf16 v[64:79], a[116:119], v[88:91], v[64:79]
    v_rcp_f32 v129, v129
    v_mul_f32 v20, v20, v126
    v_mul_f32 v21, v21, v127
    ds_read_b64_tr_b16 v[88:89], v9 offset:8192
    s_waitcnt lgkmcnt(5)
    v_mfma_f32_32x32x16_bf16 v[48:63], a[120:123], v[92:95], v[48:63]
    ds_read_b64_tr_b16 v[90:91], v9 offset:9216
    buffer_load_dwordx4 a[52:55], v11, s[8:11], s27 offen offset:1024 sc1
    v_mul_f32 v22, v22, v128
    v_mul_f32 v23, v23, v129
    v_cvt_pk_bf16_f32 v134, v20, v21
    v_mfma_f32_32x32x16_bf16 v[64:79], a[124:127], v[92:95], v[64:79]
    v_cvt_pk_bf16_f32 v135, v22, v23
    buffer_store_dwordx4 v[132:135], v11, s[8:11], s22 offen offset:0 sc1
    v_mul_f32 v126, v124, v24
    ds_read_b64_tr_b16 v[92:93], v9 offset:12288
    s_waitcnt lgkmcnt(5)
    v_mfma_f32_32x32x16_bf16 v[48:63], a[128:131], v[80:83], v[48:63]
    ds_read_b64_tr_b16 v[94:95], v9 offset:13312
    buffer_load_dwordx4 a[56:59], v11, s[8:11], s27 offen offset:2048 sc1
    v_mul_f32 v127, v124, v25
    v_mul_f32 v128, v124, v26
    v_mul_f32 v129, v124, v27
    v_mfma_f32_32x32x16_bf16 v[64:79], a[132:135], v[80:83], v[64:79]
    v_exp_f32 v126, v126
    v_mul_f32 v24, v24, v40
    ds_read_b64_tr_b16 v[80:81], v9 offset:16384
    s_waitcnt lgkmcnt(5)
    v_mfma_f32_32x32x16_bf16 v[48:63], a[136:139], v[84:87], v[48:63]
    ds_read_b64_tr_b16 v[82:83], v9 offset:17408
    buffer_load_dwordx4 a[60:63], v11, s[8:11], s27 offen offset:3072 sc1
    v_exp_f32 v127, v127
    v_mul_f32 v25, v25, v41
    v_mfma_f32_32x32x16_bf16 v[64:79], a[140:143], v[84:87], v[64:79]
    v_exp_f32 v128, v128
    v_mul_f32 v26, v26, v42
    ds_read_b64_tr_b16 v[84:85], v9 offset:20480
    s_waitcnt lgkmcnt(5)
    v_mfma_f32_32x32x16_bf16 v[48:63], a[144:147], v[88:91], v[48:63]
    ds_read_b64_tr_b16 v[86:87], v9 offset:21504
    s_add_u32 s27, s34, 49152
    buffer_load_dwordx4 a[64:67], v11, s[8:11], s27 offen offset:0 sc1
    v_exp_f32 v129, v129
    v_mfma_f32_32x32x16_bf16 v[64:79], a[148:151], v[88:91], v[64:79]
    v_mul_f32 v27, v27, v43
    v_fma_f32 v126, v126, v125, v125
    v_fma_f32 v127, v127, v125, v125
    v_fma_f32 v128, v128, v125, v125
    ds_read_b64_tr_b16 v[88:89], v9 offset:24576
    s_waitcnt lgkmcnt(5)
    v_mfma_f32_32x32x16_bf16 v[48:63], a[152:155], v[92:95], v[48:63]
    ds_read_b64_tr_b16 v[90:91], v9 offset:25600
    buffer_load_dwordx4 a[68:71], v11, s[8:11], s27 offen offset:1024 sc1
    v_fma_f32 v129, v129, v125, v125
    v_rcp_f32 v126, v126
    v_mfma_f32_32x32x16_bf16 v[64:79], a[156:159], v[92:95], v[64:79]
    v_rcp_f32 v127, v127
    v_rcp_f32 v128, v128
    ds_read_b64_tr_b16 v[92:93], v9 offset:28672
    s_waitcnt lgkmcnt(5)
    v_mfma_f32_32x32x16_bf16 v[48:63], a[160:163], v[80:83], v[48:63]
    ds_read_b64_tr_b16 v[94:95], v9 offset:29696
    buffer_load_dwordx4 a[72:75], v11, s[8:11], s27 offen offset:2048 sc1
    v_rcp_f32 v129, v129
    v_mul_f32 v24, v24, v126
    v_mfma_f32_32x32x16_bf16 v[64:79], a[164:167], v[80:83], v[64:79]
    v_mul_f32 v25, v25, v127
    v_mul_f32 v26, v26, v128
    v_mul_f32 v27, v27, v129
    v_cvt_pk_bf16_f32 v136, v24, v25
    ds_read_b64_tr_b16 v[80:81], v9 offset:32768
    s_waitcnt lgkmcnt(5)
    v_mfma_f32_32x32x16_bf16 v[48:63], a[168:171], v[84:87], v[48:63]
    ds_read_b64_tr_b16 v[82:83], v9 offset:33792
    buffer_load_dwordx4 a[76:79], v11, s[8:11], s27 offen offset:3072 sc1
    v_cvt_pk_bf16_f32 v137, v26, v27
    v_mul_f32 v126, v124, v28
    v_mul_f32 v127, v124, v29
    v_mfma_f32_32x32x16_bf16 v[64:79], a[172:175], v[84:87], v[64:79]
    v_mul_f32 v128, v124, v30
    v_mul_f32 v129, v124, v31
    v_exp_f32 v126, v126
    ds_read_b64_tr_b16 v[84:85], v9 offset:36864
    s_waitcnt lgkmcnt(5)
    v_mfma_f32_32x32x16_bf16 v[48:63], a[176:179], v[88:91], v[48:63]
    ds_read_b64_tr_b16 v[86:87], v9 offset:37888
    s_add_u32 s27, s34, 53248
    buffer_load_dwordx4 a[80:83], v11, s[8:11], s27 offen offset:0 sc1
    v_mul_f32 v28, v28, v44
    v_mfma_f32_32x32x16_bf16 v[64:79], a[180:183], v[88:91], v[64:79]
    v_exp_f32 v127, v127
    v_mul_f32 v29, v29, v45
    ds_read_b64_tr_b16 v[88:89], v9 offset:40960
    s_waitcnt lgkmcnt(5)
    v_mfma_f32_32x32x16_bf16 v[48:63], a[184:187], v[92:95], v[48:63]
    ds_read_b64_tr_b16 v[90:91], v9 offset:41984
    buffer_load_dwordx4 a[84:87], v11, s[8:11], s27 offen offset:1024 sc1
    v_exp_f32 v128, v128
    v_mul_f32 v30, v30, v46
    v_mfma_f32_32x32x16_bf16 v[64:79], a[188:191], v[92:95], v[64:79]
    v_exp_f32 v129, v129
    v_mul_f32 v31, v31, v47
    v_fma_f32 v126, v126, v125, v125
    ds_read_b64_tr_b16 v[92:93], v9 offset:45056
    s_waitcnt lgkmcnt(5)
    v_mfma_f32_32x32x16_bf16 v[48:63], a[192:195], v[80:83], v[48:63]
    ds_read_b64_tr_b16 v[94:95], v9 offset:46080
    buffer_load_dwordx4 a[88:91], v11, s[8:11], s27 offen offset:2048 sc1
    v_fma_f32 v127, v127, v125, v125
    v_fma_f32 v128, v128, v125, v125
    v_fma_f32 v129, v129, v125, v125
    v_mfma_f32_32x32x16_bf16 v[64:79], a[196:199], v[80:83], v[64:79]
    v_rcp_f32 v126, v126
    v_rcp_f32 v127, v127
    s_waitcnt lgkmcnt(4)
    v_mfma_f32_32x32x16_bf16 v[48:63], a[200:203], v[84:87], v[48:63]
    buffer_load_dwordx4 a[92:95], v11, s[8:11], s27 offen offset:3072 sc1
    v_rcp_f32 v128, v128
    v_rcp_f32 v129, v129
    v_mfma_f32_32x32x16_bf16 v[64:79], a[204:207], v[84:87], v[64:79]
    v_cvt_pk_bf16_f32 v200, -v118, -v118
    v_lshlrev_b32 v204, 16, v200
    v_sub_f32_e64 v204, -v118, v204
    v_cvt_pk_bf16_f32 v201, v204, 0
    s_waitcnt lgkmcnt(2)
    v_mfma_f32_32x32x16_bf16 v[48:63], a[208:211], v[88:91], v[48:63]
    v_mul_f32 v28, v28, v126
    v_mul_f32 v29, v29, v127
    v_mul_f32 v30, v30, v128
    v_mul_f32 v31, v31, v129
    v_cvt_pk_bf16_f32 v138, v28, v29
    v_cvt_pk_bf16_f32 v139, v30, v31
    v_mfma_f32_32x32x16_bf16 v[64:79], a[212:215], v[88:91], v[64:79]
    buffer_store_dwordx4 v[136:139], v11, s[8:11], s22 offen offset:1024 sc1
    s_waitcnt lgkmcnt(0)
    v_mfma_f32_32x32x16_bf16 v[48:63], a[216:219], v[92:95], v[48:63]
    v_mfma_f32_32x32x16_bf16 v[64:79], a[220:223], v[92:95], v[64:79]
    v_mfma_f32_32x32x16_bf16 v[48:63], v[192:195], v[200:203], v[48:63]
    v_mfma_f32_32x32x16_bf16 v[64:79], v[196:199], v[200:203], v[64:79]
    s_lshr_b32 s23, s75, 1
    s_lshl_b32 s23, s23, 8
    s_add_u32 s24, s23, 20596736
    s_add_u32 s23, s23, 20592640
    v_mov_b32 v130, 0
    s_cmp_eq_u32 s64, 0
    s_cbranch_scc0 L_ep_skip
    buffer_load_dword v131, v130, s[8:11], s23 offen sc1
L_ep_skip:
    s_add_u32 s22, s20, 344064
    v_mul_f32 v124, 0xbfb8aa3b, v119
    v_mul_f32 v126, v119, v119
    v_rcp_f32 v126, v126
    v_pk_mul_f32 v[80:81], v[48:49], v[124:125] op_sel_hi:[1,0]
    v_pk_mul_f32 v[82:83], v[50:51], v[124:125] op_sel_hi:[1,0]
    v_pk_mul_f32 v[84:85], v[52:53], v[124:125] op_sel_hi:[1,0]
    v_pk_mul_f32 v[86:87], v[54:55], v[124:125] op_sel_hi:[1,0]
    v_exp_f32 v80, v80
    v_exp_f32 v81, v81
    v_pk_mul_f32 v[48:49], v[48:49], v[64:65]
    v_exp_f32 v82, v82
    v_exp_f32 v83, v83
    v_pk_mul_f32 v[50:51], v[50:51], v[66:67]
    v_exp_f32 v84, v84
    v_exp_f32 v85, v85
    v_pk_mul_f32 v[52:53], v[52:53], v[68:69]
    v_exp_f32 v86, v86
    v_exp_f32 v87, v87
    v_pk_mul_f32 v[54:55], v[54:55], v[70:71]
    v_pk_fma_f32 v[80:81], v[80:81], v[126:127], v[126:127] op_sel_hi:[1,0,0]
    v_pk_fma_f32 v[82:83], v[82:83], v[126:127], v[126:127] op_sel_hi:[1,0,0]
    v_pk_fma_f32 v[84:85], v[84:85], v[126:127], v[126:127] op_sel_hi:[1,0,0]
    v_pk_fma_f32 v[86:87], v[86:87], v[126:127], v[126:127] op_sel_hi:[1,0,0]
    v_rcp_f32 v80, v80
    v_rcp_f32 v81, v81
    v_rcp_f32 v82, v82
    v_rcp_f32 v83, v83
    v_rcp_f32 v84, v84
    v_rcp_f32 v85, v85
    v_rcp_f32 v86, v86
    v_rcp_f32 v87, v87
    v_pk_mul_f32 v[48:49], v[48:49], v[80:81]
    v_pk_mul_f32 v[50:51], v[50:51], v[82:83]
    v_pk_mul_f32 v[52:53], v[52:53], v[84:85]
    v_pk_mul_f32 v[54:55], v[54:55], v[86:87]
    v_cvt_pk_bf16_f32 v132, v48, v49
    v_cvt_pk_bf16_f32 v133, v50, v51
    v_cvt_pk_bf16_f32 v134, v52, v53
    v_cvt_pk_bf16_f32 v135, v54, v55
    buffer_store_dwordx4 v[132:135], v11, s[8:11], s22 offen offset:0 sc1
    v_pk_mul_f32 v[88:89], v[56:57], v[124:125] op_sel_hi:[1,0]
    v_pk_mul_f32 v[90:91], v[58:59], v[124:125] op_sel_hi:[1,0]
    v_pk_mul_f32 v[92:93], v[60:61], v[124:125] op_sel_hi:[1,0]
    v_pk_mul_f32 v[94:95], v[62:63], v[124:125] op_sel_hi:[1,0]
    v_exp_f32 v88, v88
    v_exp_f32 v89, v89
    v_pk_mul_f32 v[56:57], v[56:57], v[72:73]
    v_exp_f32 v90, v90
    v_exp_f32 v91, v91
    v_pk_mul_f32 v[58:59], v[58:59], v[74:75]
    v_exp_f32 v92, v92
    v_exp_f32 v93, v93
    v_pk_mul_f32 v[60:61], v[60:61], v[76:77]
    v_exp_f32 v94, v94
    v_exp_f32 v95, v95
    v_pk_mul_f32 v[62:63], v[62:63], v[78:79]
    v_pk_fma_f32 v[88:89], v[88:89], v[126:127], v[126:127] op_sel_hi:[1,0,0]
    v_pk_fma_f32 v[90:91], v[90:91], v[126:127], v[126:127] op_sel_hi:[1,0,0]
    v_pk_fma_f32 v[92:93], v[92:93], v[126:127], v[126:127] op_sel_hi:[1,0,0]
    v_pk_fma_f32 v[94:95], v[94:95], v[126:127], v[126:127] op_sel_hi:[1,0,0]
    v_rcp_f32 v88, v88
    v_rcp_f32 v89, v89
    v_rcp_f32 v90, v90
    v_rcp_f32 v91, v91
    v_rcp_f32 v92, v92
    v_rcp_f32 v93, v93
    v_rcp_f32 v94, v94
    v_rcp_f32 v95, v95
    v_pk_mul_f32 v[56:57], v[56:57], v[88:89]
    v_pk_mul_f32 v[58:59], v[58:59], v[90:91]
    v_pk_mul_f32 v[60:61], v[60:61], v[92:93]
    v_pk_mul_f32 v[62:63], v[62:63], v[94:95]
    v_cvt_pk_bf16_f32 v136, v56, v57
    v_cvt_pk_bf16_f32 v137, v58, v59
    v_cvt_pk_bf16_f32 v138, v60, v61
    v_cvt_pk_bf16_f32 v139, v62, v63
    buffer_store_dwordx4 v[136:139], v11, s[8:11], s22 offen offset:1024 sc1
    s_cmp_eq_u32 s64, 0
    s_cbranch_scc0 L_ew_skip
    s_mov_b32 s72, 0
    s_waitcnt vmcnt(2)
    v_cmp_gt_u32 vcc, 56, v131
    s_cbranch_vccz L_fw_early_done
L_fw_early:
    buffer_load_dword v131, v130, s[8:11], s23 offen sc1
    s_add_u32 s72, s72, 1
    s_waitcnt vmcnt(0)
    v_cmp_gt_u32 vcc, 56, v131
    s_cmp_gt_u32 s72, 400000
    s_cbranch_scc1 L_fw_early_done
    s_cbranch_vccnz L_fw_early
L_fw_early_done:
L_ew_skip:
    s_barrier
    s_lshr_b32 s20, s75, 1
    s_lshl_b32 s20, s20, 2
    s_and_b32 s21, s75, 1
    s_add_u32 s20, s20, s21
    s_lshl_b32 s35, s20, 5
    s_mul_i32 s20, s20, 112
    s_mul_i32 s21, s64, 28
    s_add_u32 s20, s20, s21
    s_lshl_b32 s20, s20, 10
    s_add_u32 s20, s20, 6291456
    s_add_u32 s22, s20, 0
    buffer_load_dwordx4 a[96:99], v11, s[8:11], s22 offen offset:0 sc1
    buffer_load_dwordx4 a[100:103], v11, s[8:11], s22 offen offset:1024 sc1
    buffer_load_dwordx4 a[104:107], v11, s[8:11], s22 offen offset:2048 sc1
    buffer_load_dwordx4 a[108:111], v11, s[8:11], s22 offen offset:3072 sc1
    s_add_u32 s22, s20, 4096
    buffer_load_dwordx4 a[112:115], v11, s[8:11], s22 offen offset:0 sc1
    buffer_load_dwordx4 a[116:119], v11, s[8:11], s22 offen offset:1024 sc1
    buffer_load_dwordx4 a[120:123], v11, s[8:11], s22 offen offset:2048 sc1
    buffer_load_dwordx4 a[124:127], v11, s[8:11], s22 offen offset:3072 sc1
    s_waitcnt vmcnt(8)
    s_barrier
    s_lshl_b32 s21, s73, 8
    s_add_u32 s21, s21, 20596736
    s_cmp_eq_u32 s64, 0
    s_cbranch_scc0 L_fa_late
    s_mov_b64 exec, 1
    v_lshlrev_b32 v130, 8, v1
    v_mov_b32 v131, 1
    buffer_atomic_add v131, v130, s[8:11], s21 offen
    s_mov_b64 exec, -1
L_fa_late:
    s_add_u32 s22, s20, 8192
    buffer_load_dwordx4 a[128:131], v11, s[8:11], s22 offen offset:0 sc1
    buffer_load_dwordx4 a[132:135], v11, s[8:11], s22 offen offset:1024 sc1
    v_lshrrev_b32 v6, 2, v0
    v_lshrrev_b32 v7, 5, v6
    v_lshl_add_u32 v6, v7, 5, v6
    v_lshrrev_b32 v4, 3, v1
    v_lshlrev_b32 v4, 12, v4
    v_and_b32 v5, 3, v1
    v_lshl_add_u32 v4, v5, 4, v4
    v_bfe_u32 v5, v1, 2, 1
    v_lshl_add_u32 v4, v5, 7, v4
    s_lshl_b32 s23, s76, 18
    s_lshl_b32 s21, s35, 1
    s_add_u32 s23, s23, s21
    s_lshl_b32 s21, s64, 16
    s_add_u32 s23, s23, s21
    s_add_u32 s23, s23, 4194304
    s_lshl_b32 s21, s64, 11
    s_add_u32 m0, s21, 81920
    v_mov_b32 v130, 0
    buffer_load_dwordx4 v4, s[8:11], s23 offen sc1 lds
    s_add_u32 s23, s23, 32768
    s_add_u32 m0, s21, 82944
    s_nop 0
    buffer_load_dwordx4 v4, s[8:11], s23 offen sc1 lds
    s_waitcnt vmcnt(11)
    v_mfma_f32_32x32x16_bf16 v[16:31], v[140:143], a[96:99], 0
    v_mfma_f32_32x32x16_bf16 v[32:47], v[144:147], a[96:99], 0
    v_and_b32 v2, 31, v1
    v_lshrrev_b32 v3, 5, v1
    v_lshlrev_b32 v3, 3, v3
    v_sub_u32 v2, v2, v3
    buffer_load_dwordx4 a[136:139], v11, s[8:11], s22 offen offset:2048 sc1
    s_waitcnt vmcnt(11)
    v_mfma_f32_32x32x16_bf16 v[16:31], v[148:151], a[100:103], v[16:31]
    v_mfma_f32_32x32x16_bf16 v[32:47], v[152:155], a[100:103], v[32:47]
    v_mov_b32 v3, 0x3f80
    v_mov_b32 v5, 0x3f800000
    v_cmp_eq_u32 vcc, 0, v2
    v_cmp_eq_u32 s[28:29], 1, v2
    buffer_load_dwordx4 a[140:143], v11, s[8:11], s22 offen offset:3072 sc1
    s_waitcnt vmcnt(11)
    v_mfma_f32_32x32x16_bf16 v[16:31], v[156:159], a[104:107], v[16:31]
    v_mfma_f32_32x32x16_bf16 v[32:47], v[160:163], a[104:107], v[32:47]
    s_nop 0
    v_cndmask_b32 v80, 0, v3, vcc
    v_cndmask_b32 v80, v80, v5, s[28:29]
    v_cmp_eq_u32 vcc, 2, v2
    s_add_u32 s22, s20, 12288
    buffer_load_dwordx4 a[144:147], v11, s[8:11], s22 offen offset:0 sc1
    s_waitcnt vmcnt(11)
    v_mfma_f32_32x32x16_bf16 v[16:31], v[164:167], a[108:111], v[16:31]
    v_mfma_f32_32x32x16_bf16 v[32:47], v[168:171], a[108:111], v[32:47]
    v_cmp_eq_u32 s[28:29], 3, v2
    s_nop 0
    v_cndmask_b32 v81, 0, v3, vcc
    v_cndmask_b32 v81, v81, v5, s[28:29]
    buffer_load_dwordx4 a[148:151], v11, s[8:11], s22 offen offset:1024 sc1
    s_waitcnt vmcnt(11)
    v_mfma_f32_32x32x16_bf16 v[16:31], v[172:175], a[112:115], v[16:31]
    v_mfma_f32_32x32x16_bf16 v[32:47], v[176:179], a[112:115], v[32:47]
    v_cmp_eq_u32 vcc, 4, v2
    v_cmp_eq_u32 s[28:29], 5, v2
    s_nop 0
    v_cndmask_b32 v82, 0, v3, vcc
    buffer_load_dwordx4 a[152:155], v11, s[8:11], s22 offen offset:2048 sc1
    s_waitcnt vmcnt(11)
    v_mfma_f32_32x32x16_bf16 v[16:31], v[180:183], a[116:119], v[16:31]
    v_mfma_f32_32x32x16_bf16 v[32:47], v[184:187], a[116:119], v[32:47]
    v_cndmask_b32 v82, v82, v5, s[28:29]
    v_cmp_eq_u32 vcc, 6, v2
    v_cmp_eq_u32 s[28:29], 7, v2
    s_nop 0
    buffer_load_dwordx4 a[156:159], v11, s[8:11], s22 offen offset:3072 sc1
    s_waitcnt vmcnt(11)
    v_mfma_f32_32x32x16_bf16 v[16:31], v[188:191], a[120:123], v[16:31]
    v_mfma_f32_32x32x16_bf16 v[32:47], v[224:227], a[120:123], v[32:47]
    v_cndmask_b32 v83, 0, v3, vcc
    v_cndmask_b32 v83, v83, v5, s[28:29]
    v_cmp_eq_u32 vcc, 16, v2
    v_cmp_eq_u32 s[28:29], 17, v2
    s_add_u32 s22, s20, 16384
    buffer_load_dwordx4 a[160:163], v11, s[8:11], s22 offen offset:0 sc1
    s_waitcnt vmcnt(11)
    v_mfma_f32_32x32x16_bf16 v[16:31], v[228:231], a[124:127], v[16:31]
    v_mfma_f32_32x32x16_bf16 v[32:47], v[232:235], a[124:127], v[32:47]
    s_nop 0
    v_cndmask_b32 v84, 0, v3, vcc
    v_cndmask_b32 v84, v84, v5, s[28:29]
    v_cmp_eq_u32 vcc, 18, v2
    buffer_load_dwordx4 a[164:167], v11, s[8:11], s22 offen offset:1024 sc1
    s_waitcnt vmcnt(11)
    v_mfma_f32_32x32x16_bf16 v[16:31], v[236:239], a[128:131], v[16:31]
    v_mfma_f32_32x32x16_bf16 v[32:47], v[240:243], a[128:131], v[32:47]
    v_cmp_eq_u32 s[28:29], 19, v2
    s_nop 0
    v_cndmask_b32 v85, 0, v3, vcc
    v_cndmask_b32 v85, v85, v5, s[28:29]
    buffer_load_dwordx4 a[168:171], v11, s[8:11], s22 offen offset:2048 sc1
    s_waitcnt vmcnt(11)
    v_mfma_f32_32x32x16_bf16 v[16:31], v[244:247], a[132:135], v[16:31]
    v_mfma_f32_32x32x16_bf16 v[32:47], v[248:251], a[132:135], v[32:47]
    v_cmp_eq_u32 vcc, 20, v2
    v_cmp_eq_u32 s[28:29], 21, v2
    s_nop 0
    v_cndmask_b32 v86, 0, v3, vcc
    buffer_load_dwordx4 a[172:175], v11, s[8:11], s22 offen offset:3072 sc1
    s_waitcnt vmcnt(9)
    v_mfma_f32_32x32x16_bf16 v[16:31], v[252:255], a[136:139], v[16:31]
    v_mfma_f32_32x32x16_bf16 v[32:47], a[224:227], a[136:139], v[32:47]
    v_cndmask_b32 v86, v86, v5, s[28:29]
    v_cmp_eq_u32 vcc, 22, v2
    v_cmp_eq_u32 s[28:29], 23, v2
    s_nop 0
    s_add_u32 s22, s20, 20480
    buffer_load_dwordx4 a[176:179], v11, s[8:11], s22 offen offset:0 sc1
    s_cmp_eq_u32 s64, 0
    s_cbranch_scc0 L_lp_skip
    buffer_load_dword v131, v130, s[8:11], s24 offen sc1
L_lp_skip:
    s_waitcnt vmcnt(9)
    v_mfma_f32_32x32x16_bf16 v[16:31], a[228:231], a[140:143], v[16:31]
    v_mfma_f32_32x32x16_bf16 v[32:47], a[232:235], a[140:143], v[32:47]
    v_cndmask_b32 v87, 0, v3, vcc
    v_cndmask_b32 v87, v87, v5, s[28:29]
    v_lshrrev_b32 v2, 4, v1
    v_and_b32 v3, 15, v1
    buffer_load_dwordx4 a[180:183], v11, s[8:11], s22 offen offset:1024 sc1
    s_waitcnt vmcnt(9)
    v_mfma_f32_32x32x16_bf16 v[16:31], a[236:239], a[144:147], v[16:31]
    v_mfma_f32_32x32x16_bf16 v[32:47], a[240:243], a[144:147], v[32:47]
    v_lshrrev_b32 v5, 1, v2
    v_lshlrev_b32 v5, 3, v5
    v_lshrrev_b32 v7, 2, v3
    v_add_u32 v5, v5, v7
    buffer_load_dwordx4 a[184:187], v11, s[8:11], s22 offen offset:2048 sc1
    s_waitcnt vmcnt(9)
    v_mfma_f32_32x32x16_bf16 v[16:31], a[244:247], a[148:151], v[16:31]
    v_mfma_f32_32x32x16_bf16 v[32:47], a[248:251], a[148:151], v[32:47]
    v_lshlrev_b32 v5, 7, v5
    v_and_b32 v7, 1, v2
    v_lshl_add_u32 v5, v7, 5, v5
    v_and_b32 v7, 3, v3
    buffer_load_dwordx4 a[188:191], v11, s[8:11], s22 offen offset:3072 sc1
    s_waitcnt vmcnt(9)
    v_mfma_f32_32x32x16_bf16 v[16:31], a[252:255], a[152:155], v[16:31]
    v_mfma_f32_32x32x16_bf16 v[32:47], v[96:99], a[152:155], v[32:47]
    v_lshl_add_u32 v5, v7, 3, v5
    s_and_b32 s21, s64, 1
    s_lshl_b32 s21, s21, 12
    s_lshr_b32 s23, s64, 1
    s_add_u32 s22, s20, 24576
    buffer_load_dwordx4 a[192:195], v11, s[8:11], s22 offen offset:0 sc1
    s_waitcnt vmcnt(9)
    v_mfma_f32_32x32x16_bf16 v[16:31], v[100:103], a[156:159], v[16:31]
    v_mfma_f32_32x32x16_bf16 v[32:47], v[104:107], a[156:159], v[32:47]
    s_lshl_b32 s23, s23, 6
    s_add_u32 s21, s21, s23
    s_add_u32 s21, s21, 81920
    v_add_u32 v7, s21, v5
    buffer_load_dwordx4 a[196:199], v11, s[8:11], s22 offen offset:1024 sc1
    s_waitcnt vmcnt(9)
    v_mfma_f32_32x32x16_bf16 v[16:31], a[0:3], a[160:163], v[16:31]
    v_mfma_f32_32x32x16_bf16 v[32:47], a[4:7], a[160:163], v[32:47]
    buffer_load_dwordx4 a[200:203], v11, s[8:11], s22 offen offset:2048 sc1
    s_waitcnt vmcnt(9)
    v_mfma_f32_32x32x16_bf16 v[16:31], a[8:11], a[164:167], v[16:31]
    v_mfma_f32_32x32x16_bf16 v[32:47], a[12:15], a[164:167], v[32:47]
    buffer_load_dwordx4 a[204:207], v11, s[8:11], s22 offen offset:3072 sc1
    s_waitcnt vmcnt(9)
    v_mfma_f32_32x32x16_bf16 v[16:31], a[16:19], a[168:171], v[16:31]
    v_mfma_f32_32x32x16_bf16 v[32:47], a[20:23], a[168:171], v[32:47]
    s_cmp_eq_u32 s64, 0
    s_cbranch_scc0 L_lw_skip
    s_mov_b32 s72, 0
    s_waitcnt vmcnt(7)
    v_cmp_gt_u32 vcc, 14, v131
    s_cbranch_vccz L_fw_late_done
L_fw_late:
    buffer_load_dword v131, v130, s[8:11], s24 offen sc1
    s_add_u32 s72, s72, 1
    s_waitcnt vmcnt(0)
    v_cmp_gt_u32 vcc, 14, v131
    s_cmp_gt_u32 s72, 400000
    s_cbranch_scc1 L_fw_late_done
    s_cbranch_vccnz L_fw_late
L_fw_late_done:
L_lw_skip:
    s_barrier
    s_add_u32 s25, s20, 229376
    buffer_load_dwordx4 a[96:99], v11, s[8:11], s25 offen offset:0 sc1
    buffer_load_dwordx4 a[100:103], v11, s[8:11], s25 offen offset:1024 sc1
    s_waitcnt vmcnt(10)
    v_mfma_f32_32x32x16_bf16 v[16:31], a[24:27], a[172:175], v[16:31]
    v_mfma_f32_32x32x16_bf16 v[32:47], a[28:31], a[172:175], v[32:47]
    buffer_load_dwordx4 a[104:107], v11, s[8:11], s25 offen offset:2048 sc1
    buffer_load_dwordx4 a[108:111], v11, s[8:11], s25 offen offset:3072 sc1
    s_waitcnt vmcnt(11)
    v_mfma_f32_32x32x16_bf16 v[16:31], a[32:35], a[176:179], v[16:31]
    v_mfma_f32_32x32x16_bf16 v[32:47], a[36:39], a[176:179], v[32:47]
    s_add_u32 s25, s20, 233472
    buffer_load_dwordx4 a[112:115], v11, s[8:11], s25 offen offset:0 sc1
    buffer_load_dwordx4 a[116:119], v11, s[8:11], s25 offen offset:1024 sc1
    s_waitcnt vmcnt(12)
    v_mfma_f32_32x32x16_bf16 v[16:31], a[40:43], a[180:183], v[16:31]
    v_mfma_f32_32x32x16_bf16 v[32:47], a[44:47], a[180:183], v[32:47]
    buffer_load_dwordx4 a[120:123], v11, s[8:11], s25 offen offset:2048 sc1
    buffer_load_dwordx4 a[124:127], v11, s[8:11], s25 offen offset:3072 sc1
    s_waitcnt vmcnt(13)
    v_mfma_f32_32x32x16_bf16 v[16:31], a[48:51], a[184:187], v[16:31]
    v_mfma_f32_32x32x16_bf16 v[32:47], a[52:55], a[184:187], v[32:47]
    s_add_u32 s25, s20, 237568
    buffer_load_dwordx4 a[128:131], v11, s[8:11], s25 offen offset:0 sc1
    buffer_load_dwordx4 a[132:135], v11, s[8:11], s25 offen offset:1024 sc1
    s_waitcnt vmcnt(14)
    v_mfma_f32_32x32x16_bf16 v[16:31], a[56:59], a[188:191], v[16:31]
    v_mfma_f32_32x32x16_bf16 v[32:47], a[60:63], a[188:191], v[32:47]
    buffer_load_dwordx4 a[136:139], v11, s[8:11], s25 offen offset:2048 sc1
    buffer_load_dwordx4 a[140:143], v11, s[8:11], s25 offen offset:3072 sc1
    s_waitcnt vmcnt(15)
    v_mfma_f32_32x32x16_bf16 v[16:31], a[64:67], a[192:195], v[16:31]
    v_mfma_f32_32x32x16_bf16 v[32:47], a[68:71], a[192:195], v[32:47]
    s_waitcnt vmcnt(14)
    v_mfma_f32_32x32x16_bf16 v[16:31], a[72:75], a[196:199], v[16:31]
    v_mfma_f32_32x32x16_bf16 v[32:47], a[76:79], a[196:199], v[32:47]
    s_waitcnt vmcnt(13)
    v_mfma_f32_32x32x16_bf16 v[16:31], a[80:83], a[200:203], v[16:31]
    v_mfma_f32_32x32x16_bf16 v[32:47], a[84:87], a[200:203], v[32:47]
    s_waitcnt vmcnt(12)
    v_mfma_f32_32x32x16_bf16 v[16:31], a[88:91], a[204:207], v[16:31]
    v_mfma_f32_32x32x16_bf16 v[32:47], a[92:95], a[204:207], v[32:47]
    ds_read_b64_tr_b16 v[88:89], v7 offset:0
    ds_read_b64_tr_b16 v[90:91], v7 offset:512
    ds_read_b64_tr_b16 v[92:93], v7 offset:2048
    ds_read_b64_tr_b16 v[94:95], v7 offset:2560
    s_waitcnt vmcnt(11)
    v_mfma_f32_32x32x16_bf16 v[48:63], v[140:143], a[96:99], 0
    v_mfma_f32_32x32x16_bf16 v[64:79], v[144:147], a[96:99], 0
    s_add_u32 s25, s20, 241664
    buffer_load_dwordx4 a[144:147], v11, s[8:11], s25 offen offset:0 sc1
    s_waitcnt vmcnt(11)
    v_mfma_f32_32x32x16_bf16 v[48:63], v[148:151], a[100:103], v[48:63]
    v_mfma_f32_32x32x16_bf16 v[64:79], v[152:155], a[100:103], v[64:79]
    buffer_load_dwordx4 a[148:151], v11, s[8:11], s25 offen offset:1024 sc1
    s_waitcnt vmcnt(11)
    v_mfma_f32_32x32x16_bf16 v[48:63], v[156:159], a[104:107], v[48:63]
    v_mfma_f32_32x32x16_bf16 v[64:79], v[160:163], a[104:107], v[64:79]
    buffer_load_dwordx4 a[152:155], v11, s[8:11], s25 offen offset:2048 sc1
    s_waitcnt vmcnt(11)
    v_mfma_f32_32x32x16_bf16 v[48:63], v[164:167], a[108:111], v[48:63]
    v_mfma_f32_32x32x16_bf16 v[64:79], v[168:171], a[108:111], v[64:79]
    buffer_load_dwordx4 a[156:159], v11, s[8:11], s25 offen offset:3072 sc1
    s_waitcnt vmcnt(11)
    v_mfma_f32_32x32x16_bf16 v[48:63], v[172:175], a[112:115], v[48:63]
    v_mfma_f32_32x32x16_bf16 v[64:79], v[176:179], a[112:115], v[64:79]
    s_add_u32 s25, s20, 245760
    buffer_load_dwordx4 a[160:163], v11, s[8:11], s25 offen offset:0 sc1
    s_waitcnt vmcnt(11)
    v_mfma_f32_32x32x16_bf16 v[48:63], v[180:183], a[116:119], v[48:63]
    v_mfma_f32_32x32x16_bf16 v[64:79], v[184:187], a[116:119], v[64:79]
    buffer_load_dwordx4 a[164:167], v11, s[8:11], s25 offen offset:1024 sc1
    s_waitcnt vmcnt(11)
    v_mfma_f32_32x32x16_bf16 v[48:63], v[188:191], a[120:123], v[48:63]
    v_mfma_f32_32x32x16_bf16 v[64:79], v[224:227], a[120:123], v[64:79]
    buffer_load_dwordx4 a[168:171], v11, s[8:11], s25 offen offset:2048 sc1
    s_waitcnt vmcnt(11)
    v_mfma_f32_32x32x16_bf16 v[48:63], v[228:231], a[124:127], v[48:63]
    v_mfma_f32_32x32x16_bf16 v[64:79], v[232:235], a[124:127], v[64:79]
    buffer_load_dwordx4 a[172:175], v11, s[8:11], s25 offen offset:3072 sc1
    s_waitcnt vmcnt(11)
    v_mfma_f32_32x32x16_bf16 v[48:63], v[236:239], a[128:131], v[48:63]
    v_mfma_f32_32x32x16_bf16 v[64:79], v[240:243], a[128:131], v[64:79]
    s_add_u32 s25, s20, 249856
    buffer_load_dwordx4 a[176:179], v11, s[8:11], s25 offen offset:0 sc1
    s_waitcnt vmcnt(11)
    v_mfma_f32_32x32x16_bf16 v[48:63], v[244:247], a[132:135], v[48:63]
    v_mfma_f32_32x32x16_bf16 v[64:79], v[248:251], a[132:135], v[64:79]
    buffer_load_dwordx4 a[180:183], v11, s[8:11], s25 offen offset:1024 sc1
    s_waitcnt vmcnt(11)
    v_mfma_f32_32x32x16_bf16 v[48:63], v[252:255], a[136:139], v[48:63]
    v_mfma_f32_32x32x16_bf16 v[64:79], a[224:227], a[136:139], v[64:79]
    buffer_load_dwordx4 a[184:187], v11, s[8:11], s25 offen offset:2048 sc1
    s_waitcnt vmcnt(11)
    v_mfma_f32_32x32x16_bf16 v[48:63], a[228:231], a[140:143], v[48:63]
    v_mfma_f32_32x32x16_bf16 v[64:79], a[232:235], a[140:143], v[64:79]
    buffer_load_dwordx4 a[188:191], v11, s[8:11], s25 offen offset:3072 sc1
    s_waitcnt vmcnt(11)
    v_mfma_f32_32x32x16_bf16 v[48:63], a[236:239], a[144:147], v[48:63]
    v_mfma_f32_32x32x16_bf16 v[64:79], a[240:243], a[144:147], v[64:79]
    s_add_u32 s25, s20, 253952
    buffer_load_dwordx4 a[192:195], v11, s[8:11], s25 offen offset:0 sc1
    s_waitcnt vmcnt(11)
    v_mfma_f32_32x32x16_bf16 v[48:63], a[244:247], a[148:151], v[48:63]
    v_mfma_f32_32x32x16_bf16 v[64:79], a[248:251], a[148:151], v[64:79]
    buffer_load_dwordx4 a[196:199], v11, s[8:11], s25 offen offset:1024 sc1
    s_waitcnt vmcnt(11)
    v_mfma_f32_32x32x16_bf16 v[48:63], a[252:255], a[152:155], v[48:63]
    v_mfma_f32_32x32x16_bf16 v[64:79], v[96:99], a[152:155], v[64:79]
    buffer_load_dwordx4 a[200:203], v11, s[8:11], s25 offen offset:2048 sc1
    s_waitcnt vmcnt(11)
    v_mfma_f32_32x32x16_bf16 v[48:63], v[100:103], a[156:159], v[48:63]
    v_mfma_f32_32x32x16_bf16 v[64:79], v[104:107], a[156:159], v[64:79]
    buffer_load_dwordx4 a[204:207], v11, s[8:11], s25 offen offset:3072 sc1
    s_waitcnt vmcnt(11)
    v_mfma_f32_32x32x16_bf16 v[48:63], a[0:3], a[160:163], v[48:63]
    v_mfma_f32_32x32x16_bf16 v[64:79], a[4:7], a[160:163], v[64:79]
    s_waitcnt vmcnt(10)
    v_mfma_f32_32x32x16_bf16 v[48:63], a[8:11], a[164:167], v[48:63]
    v_mfma_f32_32x32x16_bf16 v[64:79], a[12:15], a[164:167], v[64:79]
    s_waitcnt vmcnt(9)
    v_mfma_f32_32x32x16_bf16 v[48:63], a[16:19], a[168:171], v[48:63]
    v_mfma_f32_32x32x16_bf16 v[64:79], a[20:23], a[168:171], v[64:79]
    s_waitcnt vmcnt(8)
    v_mfma_f32_32x32x16_bf16 v[48:63], a[24:27], a[172:175], v[48:63]
    v_mfma_f32_32x32x16_bf16 v[64:79], a[28:31], a[172:175], v[64:79]
    s_waitcnt vmcnt(7)
    v_mfma_f32_32x32x16_bf16 v[48:63], a[32:35], a[176:179], v[48:63]
    v_mfma_f32_32x32x16_bf16 v[64:79], a[36:39], a[176:179], v[64:79]
    s_waitcnt vmcnt(6)
    v_mfma_f32_32x32x16_bf16 v[48:63], a[40:43], a[180:183], v[48:63]
    v_mfma_f32_32x32x16_bf16 v[64:79], a[44:47], a[180:183], v[64:79]
    s_waitcnt vmcnt(5)
    v_mfma_f32_32x32x16_bf16 v[48:63], a[48:51], a[184:187], v[48:63]
    v_mfma_f32_32x32x16_bf16 v[64:79], a[52:55], a[184:187], v[64:79]
    s_waitcnt vmcnt(4)
    v_mfma_f32_32x32x16_bf16 v[48:63], a[56:59], a[188:191], v[48:63]
    v_mfma_f32_32x32x16_bf16 v[64:79], a[60:63], a[188:191], v[64:79]
    s_waitcnt vmcnt(3)
    v_mfma_f32_32x32x16_bf16 v[48:63], a[64:67], a[192:195], v[48:63]
    v_mfma_f32_32x32x16_bf16 v[64:79], a[68:71], a[192:195], v[64:79]
    s_waitcnt vmcnt(2)
    v_mfma_f32_32x32x16_bf16 v[48:63], a[72:75], a[196:199], v[48:63]
    v_mfma_f32_32x32x16_bf16 v[64:79], a[76:79], a[196:199], v[64:79]
    s_waitcnt vmcnt(1)
    v_mfma_f32_32x32x16_bf16 v[48:63], a[80:83], a[200:203], v[48:63]
    v_mfma_f32_32x32x16_bf16 v[64:79], a[84:87], a[200:203], v[64:79]
    s_waitcnt vmcnt(0)
    v_mfma_f32_32x32x16_bf16 v[48:63], a[88:91], a[204:207], v[48:63]
    v_mfma_f32_32x32x16_bf16 v[64:79], a[92:95], a[204:207], v[64:79]
    s_waitcnt lgkmcnt(0)
    s_cmp_eq_u32 s64, 0
    s_cbranch_scc0 L_hr0
    v_mfma_f32_32x32x16_bf16 v[16:31], v[80:83], v[88:91], v[16:31]
    v_mfma_f32_32x32x16_bf16 v[16:31], v[84:87], v[92:95], v[16:31]
L_hr0:
    s_cmp_eq_u32 s64, 1
    s_cbranch_scc0 L_hr1
    v_mfma_f32_32x32x16_bf16 v[32:47], v[80:83], v[88:91], v[32:47]
    v_mfma_f32_32x32x16_bf16 v[32:47], v[84:87], v[92:95], v[32:47]
L_hr1:
    s_cmp_eq_u32 s64, 2
    s_cbranch_scc0 L_hr2
    v_mfma_f32_32x32x16_bf16 v[48:63], v[80:83], v[88:91], v[48:63]
    v_mfma_f32_32x32x16_bf16 v[48:63], v[84:87], v[92:95], v[48:63]
L_hr2:
    s_cmp_eq_u32 s64, 3
    s_cbranch_scc0 L_hr3
    v_mfma_f32_32x32x16_bf16 v[64:79], v[80:83], v[88:91], v[64:79]
    v_mfma_f32_32x32x16_bf16 v[64:79], v[84:87], v[92:95], v[64:79]
L_hr3:
    v_and_b32 v3, 31, v1
    v_mul_u32_u24 v3, 272, v3
    v_lshrrev_b32 v4, 5, v1
    v_lshl_add_u32 v3, v4, 4, v3
    s_mul_i32 s21, s64, 17408
    v_add_u32 v3, s21, v3
    v_lshrrev_b32 v4, 2, v0
    v_mul_u32_u24 v4, 272, v4
    v_and_b32 v5, 3, v0
    v_lshl_add_u32 v4, v5, 6, v4
    ds_write_b128 v3, v[16:19] offset:0
    ds_write_b128 v3, v[20:23] offset:32
    ds_write_b128 v3, v[24:27] offset:64
    ds_write_b128 v3, v[28:31] offset:96
    ds_write_b128 v3, v[32:35] offset:128
    ds_write_b128 v3, v[36:39] offset:160
    ds_write_b128 v3, v[40:43] offset:192
    ds_write_b128 v3, v[44:47] offset:224
    ds_write_b128 v3, v[48:51] offset:8704
    ds_write_b128 v3, v[52:55] offset:8736
    ds_write_b128 v3, v[56:59] offset:8768
    ds_write_b128 v3, v[60:63] offset:8800
    ds_write_b128 v3, v[64:67] offset:8832
    ds_write_b128 v3, v[68:71] offset:8864
    ds_write_b128 v3, v[72:75] offset:8896
    ds_write_b128 v3, v[76:79] offset:8928
    s_mov_b32 s4, s58
    s_and_b32 s5, s59, 0xffff
    s_mov_b32 s6, 1835008
    s_mov_b32 s7, 0x20000
    v_mul_u32_u24 v6, 896, v6
    v_lshl_add_u32 v6, v5, 5, v6
    s_mul_i32 s21, s35, 896
    s_lshl_b32 s22, s76, 7
    s_add_u32 s21, s21, s22
    s_waitcnt lgkmcnt(0)
    s_barrier
    ds_read_b128 v[96:99], v4 offset:0
    ds_read_b128 v[100:103], v4 offset:16
    ds_read_b128 v[104:107], v4 offset:32
    ds_read_b128 v[108:111], v4 offset:48
    ds_read_b128 v[112:115], v4 offset:17408
    ds_read_b128 v[116:119], v4 offset:17424
    ds_read_b128 v[120:123], v4 offset:17440
    ds_read_b128 v[124:127], v4 offset:17456
    ds_read_b128 v[128:131], v4 offset:34816
    ds_read_b128 v[132:135], v4 offset:34832
    ds_read_b128 v[136:139], v4 offset:34848
    ds_read_b128 v[140:143], v4 offset:34864
    s_waitcnt lgkmcnt(4)
    ds_read_b128 v[144:147], v4 offset:52224
    ds_read_b128 v[148:151], v4 offset:52240
    ds_read_b128 v[152:155], v4 offset:52256
    ds_read_b128 v[156:159], v4 offset:52272
    s_waitcnt lgkmcnt(8)
    v_pk_add_f32 v[96:97], v[96:97], v[112:113]
    v_pk_add_f32 v[98:99], v[98:99], v[114:115]
    v_pk_add_f32 v[100:101], v[100:101], v[116:117]
    v_pk_add_f32 v[102:103], v[102:103], v[118:119]
    v_pk_add_f32 v[104:105], v[104:105], v[120:121]
    v_pk_add_f32 v[106:107], v[106:107], v[122:123]
    v_pk_add_f32 v[108:109], v[108:109], v[124:125]
    v_pk_add_f32 v[110:111], v[110:111], v[126:127]
    s_waitcnt lgkmcnt(0)
    v_pk_add_f32 v[128:129], v[128:129], v[144:145]
    v_pk_add_f32 v[130:131], v[130:131], v[146:147]
    v_pk_add_f32 v[132:133], v[132:133], v[148:149]
    v_pk_add_f32 v[134:135], v[134:135], v[150:151]
    v_pk_add_f32 v[136:137], v[136:137], v[152:153]
    v_pk_add_f32 v[138:139], v[138:139], v[154:155]
    v_pk_add_f32 v[140:141], v[140:141], v[156:157]
    v_pk_add_f32 v[142:143], v[142:143], v[158:159]
    v_pk_add_f32 v[96:97], v[96:97], v[128:129]
    v_pk_add_f32 v[98:99], v[98:99], v[130:131]
    v_pk_add_f32 v[100:101], v[100:101], v[132:133]
    v_pk_add_f32 v[102:103], v[102:103], v[134:135]
    v_pk_add_f32 v[104:105], v[104:105], v[136:137]
    v_pk_add_f32 v[106:107], v[106:107], v[138:139]
    v_pk_add_f32 v[108:109], v[108:109], v[140:141]
    v_pk_add_f32 v[110:111], v[110:111], v[142:143]
    v_cvt_pk_bf16_f32 v16, v96, v97
    v_cvt_pk_bf16_f32 v17, v98, v99
    v_cvt_pk_bf16_f32 v18, v100, v101
    v_cvt_pk_bf16_f32 v19, v102, v103
    v_cvt_pk_bf16_f32 v20, v104, v105
    v_cvt_pk_bf16_f32 v21, v106, v107
    v_cvt_pk_bf16_f32 v22, v108, v109
    v_cvt_pk_bf16_f32 v23, v110, v111
    buffer_store_dwordx4 v[16:19], v6, s[4:7], s21 offen
    buffer_store_dwordx4 v[20:23], v6, s[4:7], s21 offen offset:16
    s_branch L_end
L_helper:
    s_waitcnt lgkmcnt(0)
    s_mov_b32 s8, s62
    s_and_b32 s9, s63, 0xffff
    s_mov_b32 s10, 33554432
    s_mov_b32 s11, 0x20000
    s_mov_b32 s4, s36
    s_and_b32 s5, s37, 0xffff
    s_mov_b32 s6, 1835008
    s_mov_b32 s7, 0x20000
    s_lshl_b32 s20, s2, 2
    s_add_u32 s20, s20, s64
    s_mul_i32 s21, s20, 896
    v_lshlrev_b32 v80, 4, v1
    v_cmp_gt_u32 vcc, 56, v1
    v_mov_b32 v81, 0x40000000
    s_nop 0
    v_cndmask_b32 v80, v81, v80, vcc
    s_add_u32 s22, s21, 0
    buffer_load_dwordx4 v[100:103], v80, s[4:7], s22 offen
    s_add_u32 s22, s21, 100352
    buffer_load_dwordx4 v[104:107], v80, s[4:7], s22 offen
    s_add_u32 s22, s21, 200704
    buffer_load_dwordx4 v[108:111], v80, s[4:7], s22 offen
    s_add_u32 s22, s21, 301056
    buffer_load_dwordx4 v[112:115], v80, s[4:7], s22 offen
    s_add_u32 s22, s21, 401408
    buffer_load_dwordx4 v[116:119], v80, s[4:7], s22 offen
    s_add_u32 s22, s21, 501760
    buffer_load_dwordx4 v[120:123], v80, s[4:7], s22 offen
    s_add_u32 s22, s21, 602112
    buffer_load_dwordx4 v[124:127], v80, s[4:7], s22 offen
    s_add_u32 s22, s21, 702464
    buffer_load_dwordx4 v[128:131], v80, s[4:7], s22 offen
    s_add_u32 s22, s21, 802816
    buffer_load_dwordx4 v[132:135], v80, s[4:7], s22 offen
    s_add_u32 s22, s21, 903168
    buffer_load_dwordx4 v[136:139], v80, s[4:7], s22 offen
    s_add_u32 s22, s21, 1003520
    buffer_load_dwordx4 v[140:143], v80, s[4:7], s22 offen
    s_add_u32 s22, s21, 1103872
    buffer_load_dwordx4 v[144:147], v80, s[4:7], s22 offen
    s_add_u32 s22, s21, 1204224
    buffer_load_dwordx4 v[148:151], v80, s[4:7], s22 offen
    s_add_u32 s22, s21, 1304576
    buffer_load_dwordx4 v[152:155], v80, s[4:7], s22 offen
    s_add_u32 s22, s21, 1404928
    buffer_load_dwordx4 v[156:159], v80, s[4:7], s22 offen
    s_add_u32 s22, s21, 1505280
    buffer_load_dwordx4 v[160:163], v80, s[4:7], s22 offen
    s_add_u32 s22, s21, 1605632
    buffer_load_dwordx4 v[164:167], v80, s[4:7], s22 offen
    s_add_u32 s22, s21, 1705984
    buffer_load_dwordx4 v[168:171], v80, s[4:7], s22 offen
    s_add_u32 s22, s21, 1806336
    buffer_load_dwordx4 v[172:175], v80, s[4:7], s22 offen
    s_add_u32 s22, s21, 1906688
    buffer_load_dwordx4 v[176:179], v80, s[4:7], s22 offen
    s_mul_i32 s22, s2, 1536
    s_add_u32 s22, s22, 20578304
    v_lshlrev_b32 v16, 8, v1
    v_mov_b32 v17, 0
    s_cmp_eq_u32 s64, 0
    s_cbranch_scc0 L_h_nozero
    s_mov_b64 exec, 0x3f
    buffer_store_dword v17, v16, s[8:11], s22 offen sc1
    s_mov_b64 exec, -1
L_h_nozero:
    v_lshrrev_b32 v30, 4, v1
    s_waitcnt vmcnt(16)
    v_mov_b32 v20, 0
    v_mov_b32 v21, 0
    v_mov_b32 v22, 0
    v_mov_b32 v23, 0
    v_mov_b32 v24, 0
    v_mov_b32 v25, 0
    v_mov_b32 v26, 0
    v_mov_b32 v27, 0
    v_dot2c_f32_bf16 v20, s71, v100
    v_dot2c_f32_bf16 v24, v100, v100
    v_dot2c_f32_bf16 v21, s71, v104
    v_dot2c_f32_bf16 v25, v104, v104
    v_dot2c_f32_bf16 v22, s71, v108
    v_dot2c_f32_bf16 v26, v108, v108
    v_dot2c_f32_bf16 v23, s71, v112
    v_dot2c_f32_bf16 v27, v112, v112
    v_dot2c_f32_bf16 v20, s71, v101
    v_dot2c_f32_bf16 v24, v101, v101
    v_dot2c_f32_bf16 v21, s71, v105
    v_dot2c_f32_bf16 v25, v105, v105
    v_dot2c_f32_bf16 v22, s71, v109
    v_dot2c_f32_bf16 v26, v109, v109
    v_dot2c_f32_bf16 v23, s71, v113
    v_dot2c_f32_bf16 v27, v113, v113
    v_dot2c_f32_bf16 v20, s71, v102
    v_dot2c_f32_bf16 v24, v102, v102
    v_dot2c_f32_bf16 v21, s71, v106
    v_dot2c_f32_bf16 v25, v106, v106
    v_dot2c_f32_bf16 v22, s71, v110
    v_dot2c_f32_bf16 v26, v110, v110
    v_dot2c_f32_bf16 v23, s71, v114
    v_dot2c_f32_bf16 v27, v114, v114
    v_dot2c_f32_bf16 v20, s71, v103
    v_dot2c_f32_bf16 v24, v103, v103
    v_dot2c_f32_bf16 v21, s71, v107
    v_dot2c_f32_bf16 v25, v107, v107
    v_dot2c_f32_bf16 v22, s71, v111
    v_dot2c_f32_bf16 v26, v111, v111
    v_dot2c_f32_bf16 v23, s71, v115
    v_dot2c_f32_bf16 v27, v115, v115
    v_permlane32_swap_b32 v20, v22
    s_nop 0
    v_permlane32_swap_b32 v21, v23
    v_permlane32_swap_b32 v24, v26
    v_permlane32_swap_b32 v25, v27
    v_add_f32 v20, v20, v22
    v_add_f32 v21, v21, v23
    v_add_f32 v24, v24, v26
    v_add_f32 v25, v25, v27
    v_permlane16_swap_b32 v20, v21
    s_nop 0
    v_permlane16_swap_b32 v24, v25
    v_add_f32 v20, v20, v21
    v_add_f32 v24, v24, v25
    s_nop 0
    v_add_f32_dpp v20, v20, v20 quad_perm:[1,0,3,2] row_mask:0xf bank_mask:0xf
    v_add_f32_dpp v24, v24, v24 quad_perm:[1,0,3,2] row_mask:0xf bank_mask:0xf
    s_nop 0
    v_add_f32_dpp v20, v20, v20 quad_perm:[2,3,0,1] row_mask:0xf bank_mask:0xf
    v_add_f32_dpp v24, v24, v24 quad_perm:[2,3,0,1] row_mask:0xf bank_mask:0xf
    s_nop 0
    v_add_f32_dpp v20, v20, v20 row_half_mirror row_mask:0xf bank_mask:0xf
    v_add_f32_dpp v24, v24, v24 row_half_mirror row_mask:0xf bank_mask:0xf
    s_nop 0
    v_add_f32_dpp v20, v20, v20 row_mirror row_mask:0xf bank_mask:0xf
    v_add_f32_dpp v24, v24, v24 row_mirror row_mask:0xf bank_mask:0xf
    v_mul_f32 v20, 0x3b124925, v20
    v_mul_f32 v24, 0x3b124925, v24
    v_fma_f32 v24, -v20, v20, v24
    v_max_f32 v24, 0, v24
    v_add_f32 v24, 0x3727c5ac, v24
    v_rsq_f32 v22, v24
    v_add_u32 v26, 0, v30
    v_mul_u32_u24 v26, 112, v26
    v_add_u32 v26, s20, v26
    v_bfe_u32 v27, v26, 1, 2
    v_lshlrev_b32 v27, 12, v27
    v_lshrrev_b32 v28, 3, v26
    v_lshl_add_u32 v27, v28, 4, v27
    v_and_b32 v28, 1, v26
    v_lshl_add_u32 v27, v28, 3, v27
    v_mov_b32 v28, 0x40000000
    v_cmp_gt_u32 vcc, 2048, v26
    v_mul_f32 v23, v20, v22
    s_mov_b32 s23, 0
    v_cndmask_b32 v27, v28, v27, vcc
    s_mov_b32 s28, 0x00010001
    s_mov_b32 s29, 0x00010001
    s_mov_b64 exec, s[28:29]
    buffer_store_dwordx2 v[22:23], v27, s[8:11], s23 offen sc1
    s_mov_b64 exec, -1
    s_waitcnt vmcnt(13)
    v_mov_b32 v20, 0
    v_mov_b32 v21, 0
    v_mov_b32 v22, 0
    v_mov_b32 v23, 0
    v_mov_b32 v24, 0
    v_mov_b32 v25, 0
    v_mov_b32 v26, 0
    v_mov_b32 v27, 0
    v_dot2c_f32_bf16 v20, s71, v116
    v_dot2c_f32_bf16 v24, v116, v116
    v_dot2c_f32_bf16 v21, s71, v120
    v_dot2c_f32_bf16 v25, v120, v120
    v_dot2c_f32_bf16 v22, s71, v124
    v_dot2c_f32_bf16 v26, v124, v124
    v_dot2c_f32_bf16 v23, s71, v128
    v_dot2c_f32_bf16 v27, v128, v128
    v_dot2c_f32_bf16 v20, s71, v117
    v_dot2c_f32_bf16 v24, v117, v117
    v_dot2c_f32_bf16 v21, s71, v121
    v_dot2c_f32_bf16 v25, v121, v121
    v_dot2c_f32_bf16 v22, s71, v125
    v_dot2c_f32_bf16 v26, v125, v125
    v_dot2c_f32_bf16 v23, s71, v129
    v_dot2c_f32_bf16 v27, v129, v129
    v_dot2c_f32_bf16 v20, s71, v118
    v_dot2c_f32_bf16 v24, v118, v118
    v_dot2c_f32_bf16 v21, s71, v122
    v_dot2c_f32_bf16 v25, v122, v122
    v_dot2c_f32_bf16 v22, s71, v126
    v_dot2c_f32_bf16 v26, v126, v126
    v_dot2c_f32_bf16 v23, s71, v130
    v_dot2c_f32_bf16 v27, v130, v130
    v_dot2c_f32_bf16 v20, s71, v119
    v_dot2c_f32_bf16 v24, v119, v119
    v_dot2c_f32_bf16 v21, s71, v123
    v_dot2c_f32_bf16 v25, v123, v123
    v_dot2c_f32_bf16 v22, s71, v127
    v_dot2c_f32_bf16 v26, v127, v127
    v_dot2c_f32_bf16 v23, s71, v131
    v_dot2c_f32_bf16 v27, v131, v131
    v_permlane32_swap_b32 v20, v22
    s_nop 0
    v_permlane32_swap_b32 v21, v23
    v_permlane32_swap_b32 v24, v26
    v_permlane32_swap_b32 v25, v27
    v_add_f32 v20, v20, v22
    v_add_f32 v21, v21, v23
    v_add_f32 v24, v24, v26
    v_add_f32 v25, v25, v27
    v_permlane16_swap_b32 v20, v21
    s_nop 0
    v_permlane16_swap_b32 v24, v25
    v_add_f32 v20, v20, v21
    v_add_f32 v24, v24, v25
    s_nop 0
    v_add_f32_dpp v20, v20, v20 quad_perm:[1,0,3,2] row_mask:0xf bank_mask:0xf
    v_add_f32_dpp v24, v24, v24 quad_perm:[1,0,3,2] row_mask:0xf bank_mask:0xf
    s_nop 0
    v_add_f32_dpp v20, v20, v20 quad_perm:[2,3,0,1] row_mask:0xf bank_mask:0xf
    v_add_f32_dpp v24, v24, v24 quad_perm:[2,3,0,1] row_mask:0xf bank_mask:0xf
    s_nop 0
    v_add_f32_dpp v20, v20, v20 row_half_mirror row_mask:0xf bank_mask:0xf
    v_add_f32_dpp v24, v24, v24 row_half_mirror row_mask:0xf bank_mask:0xf
    s_nop 0
    v_add_f32_dpp v20, v20, v20 row_mirror row_mask:0xf bank_mask:0xf
    v_add_f32_dpp v24, v24, v24 row_mirror row_mask:0xf bank_mask:0xf
    v_mul_f32 v20, 0x3b124925, v20
    v_mul_f32 v24, 0x3b124925, v24
    v_fma_f32 v24, -v20, v20, v24
    v_max_f32 v24, 0, v24
    v_add_f32 v24, 0x3727c5ac, v24
    v_rsq_f32 v22, v24
    v_add_u32 v26, 4, v30
    v_mul_u32_u24 v26, 112, v26
    v_add_u32 v26, s20, v26
    v_bfe_u32 v27, v26, 1, 2
    v_lshlrev_b32 v27, 12, v27
    v_lshrrev_b32 v28, 3, v26
    v_lshl_add_u32 v27, v28, 4, v27
    v_and_b32 v28, 1, v26
    v_lshl_add_u32 v27, v28, 3, v27
    v_mov_b32 v28, 0x40000000
    v_cmp_gt_u32 vcc, 2048, v26
    v_mul_f32 v23, v20, v22
    s_mov_b32 s23, 0
    v_cndmask_b32 v27, v28, v27, vcc
    s_mov_b32 s28, 0x00010001
    s_mov_b32 s29, 0x00010001
    s_mov_b64 exec, s[28:29]
    buffer_store_dwordx2 v[22:23], v27, s[8:11], s23 offen sc1
    s_mov_b64 exec, -1
    s_waitcnt vmcnt(10)
    v_mov_b32 v20, 0
    v_mov_b32 v21, 0
    v_mov_b32 v22, 0
    v_mov_b32 v23, 0
    v_mov_b32 v24, 0
    v_mov_b32 v25, 0
    v_mov_b32 v26, 0
    v_mov_b32 v27, 0
    v_dot2c_f32_bf16 v20, s71, v132
    v_dot2c_f32_bf16 v24, v132, v132
    v_dot2c_f32_bf16 v21, s71, v136
    v_dot2c_f32_bf16 v25, v136, v136
    v_dot2c_f32_bf16 v22, s71, v140
    v_dot2c_f32_bf16 v26, v140, v140
    v_dot2c_f32_bf16 v23, s71, v144
    v_dot2c_f32_bf16 v27, v144, v144
    v_dot2c_f32_bf16 v20, s71, v133
    v_dot2c_f32_bf16 v24, v133, v133
    v_dot2c_f32_bf16 v21, s71, v137
    v_dot2c_f32_bf16 v25, v137, v137
    v_dot2c_f32_bf16 v22, s71, v141
    v_dot2c_f32_bf16 v26, v141, v141
    v_dot2c_f32_bf16 v23, s71, v145
    v_dot2c_f32_bf16 v27, v145, v145
    v_dot2c_f32_bf16 v20, s71, v134
    v_dot2c_f32_bf16 v24, v134, v134
    v_dot2c_f32_bf16 v21, s71, v138
    v_dot2c_f32_bf16 v25, v138, v138
    v_dot2c_f32_bf16 v22, s71, v142
    v_dot2c_f32_bf16 v26, v142, v142
    v_dot2c_f32_bf16 v23, s71, v146
    v_dot2c_f32_bf16 v27, v146, v146
    v_dot2c_f32_bf16 v20, s71, v135
    v_dot2c_f32_bf16 v24, v135, v135
    v_dot2c_f32_bf16 v21, s71, v139
    v_dot2c_f32_bf16 v25, v139, v139
    v_dot2c_f32_bf16 v22, s71, v143
    v_dot2c_f32_bf16 v26, v143, v143
    v_dot2c_f32_bf16 v23, s71, v147
    v_dot2c_f32_bf16 v27, v147, v147
    v_permlane32_swap_b32 v20, v22
    s_nop 0
    v_permlane32_swap_b32 v21, v23
    v_permlane32_swap_b32 v24, v26
    v_permlane32_swap_b32 v25, v27
    v_add_f32 v20, v20, v22
    v_add_f32 v21, v21, v23
    v_add_f32 v24, v24, v26
    v_add_f32 v25, v25, v27
    v_permlane16_swap_b32 v20, v21
    s_nop 0
    v_permlane16_swap_b32 v24, v25
    v_add_f32 v20, v20, v21
    v_add_f32 v24, v24, v25
    s_nop 0
    v_add_f32_dpp v20, v20, v20 quad_perm:[1,0,3,2] row_mask:0xf bank_mask:0xf
    v_add_f32_dpp v24, v24, v24 quad_perm:[1,0,3,2] row_mask:0xf bank_mask:0xf
    s_nop 0
    v_add_f32_dpp v20, v20, v20 quad_perm:[2,3,0,1] row_mask:0xf bank_mask:0xf
    v_add_f32_dpp v24, v24, v24 quad_perm:[2,3,0,1] row_mask:0xf bank_mask:0xf
    s_nop 0
    v_add_f32_dpp v20, v20, v20 row_half_mirror row_mask:0xf bank_mask:0xf
    v_add_f32_dpp v24, v24, v24 row_half_mirror row_mask:0xf bank_mask:0xf
    s_nop 0
    v_add_f32_dpp v20, v20, v20 row_mirror row_mask:0xf bank_mask:0xf
    v_add_f32_dpp v24, v24, v24 row_mirror row_mask:0xf bank_mask:0xf
    v_mul_f32 v20, 0x3b124925, v20
    v_mul_f32 v24, 0x3b124925, v24
    v_fma_f32 v24, -v20, v20, v24
    v_max_f32 v24, 0, v24
    v_add_f32 v24, 0x3727c5ac, v24
    v_rsq_f32 v22, v24
    v_add_u32 v26, 8, v30
    v_mul_u32_u24 v26, 112, v26
    v_add_u32 v26, s20, v26
    v_bfe_u32 v27, v26, 1, 2
    v_lshlrev_b32 v27, 12, v27
    v_lshrrev_b32 v28, 3, v26
    v_lshl_add_u32 v27, v28, 4, v27
    v_and_b32 v28, 1, v26
    v_lshl_add_u32 v27, v28, 3, v27
    v_mov_b32 v28, 0x40000000
    v_cmp_gt_u32 vcc, 2048, v26
    v_mul_f32 v23, v20, v22
    s_mov_b32 s23, 0
    v_cndmask_b32 v27, v28, v27, vcc
    s_mov_b32 s28, 0x00010001
    s_mov_b32 s29, 0x00010001
    s_mov_b64 exec, s[28:29]
    buffer_store_dwordx2 v[22:23], v27, s[8:11], s23 offen sc1
    s_mov_b64 exec, -1
    s_waitcnt vmcnt(7)
    v_mov_b32 v20, 0
    v_mov_b32 v21, 0
    v_mov_b32 v22, 0
    v_mov_b32 v23, 0
    v_mov_b32 v24, 0
    v_mov_b32 v25, 0
    v_mov_b32 v26, 0
    v_mov_b32 v27, 0
    v_dot2c_f32_bf16 v20, s71, v148
    v_dot2c_f32_bf16 v24, v148, v148
    v_dot2c_f32_bf16 v21, s71, v152
    v_dot2c_f32_bf16 v25, v152, v152
    v_dot2c_f32_bf16 v22, s71, v156
    v_dot2c_f32_bf16 v26, v156, v156
    v_dot2c_f32_bf16 v23, s71, v160
    v_dot2c_f32_bf16 v27, v160, v160
    v_dot2c_f32_bf16 v20, s71, v149
    v_dot2c_f32_bf16 v24, v149, v149
    v_dot2c_f32_bf16 v21, s71, v153
    v_dot2c_f32_bf16 v25, v153, v153
    v_dot2c_f32_bf16 v22, s71, v157
    v_dot2c_f32_bf16 v26, v157, v157
    v_dot2c_f32_bf16 v23, s71, v161
    v_dot2c_f32_bf16 v27, v161, v161
    v_dot2c_f32_bf16 v20, s71, v150
    v_dot2c_f32_bf16 v24, v150, v150
    v_dot2c_f32_bf16 v21, s71, v154
    v_dot2c_f32_bf16 v25, v154, v154
    v_dot2c_f32_bf16 v22, s71, v158
    v_dot2c_f32_bf16 v26, v158, v158
    v_dot2c_f32_bf16 v23, s71, v162
    v_dot2c_f32_bf16 v27, v162, v162
    v_dot2c_f32_bf16 v20, s71, v151
    v_dot2c_f32_bf16 v24, v151, v151
    v_dot2c_f32_bf16 v21, s71, v155
    v_dot2c_f32_bf16 v25, v155, v155
    v_dot2c_f32_bf16 v22, s71, v159
    v_dot2c_f32_bf16 v26, v159, v159
    v_dot2c_f32_bf16 v23, s71, v163
    v_dot2c_f32_bf16 v27, v163, v163
    v_permlane32_swap_b32 v20, v22
    s_nop 0
    v_permlane32_swap_b32 v21, v23
    v_permlane32_swap_b32 v24, v26
    v_permlane32_swap_b32 v25, v27
    v_add_f32 v20, v20, v22
    v_add_f32 v21, v21, v23
    v_add_f32 v24, v24, v26
    v_add_f32 v25, v25, v27
    v_permlane16_swap_b32 v20, v21
    s_nop 0
    v_permlane16_swap_b32 v24, v25
    v_add_f32 v20, v20, v21
    v_add_f32 v24, v24, v25
    s_nop 0
    v_add_f32_dpp v20, v20, v20 quad_perm:[1,0,3,2] row_mask:0xf bank_mask:0xf
    v_add_f32_dpp v24, v24, v24 quad_perm:[1,0,3,2] row_mask:0xf bank_mask:0xf
    s_nop 0
    v_add_f32_dpp v20, v20, v20 quad_perm:[2,3,0,1] row_mask:0xf bank_mask:0xf
    v_add_f32_dpp v24, v24, v24 quad_perm:[2,3,0,1] row_mask:0xf bank_mask:0xf
    s_nop 0
    v_add_f32_dpp v20, v20, v20 row_half_mirror row_mask:0xf bank_mask:0xf
    v_add_f32_dpp v24, v24, v24 row_half_mirror row_mask:0xf bank_mask:0xf
    s_nop 0
    v_add_f32_dpp v20, v20, v20 row_mirror row_mask:0xf bank_mask:0xf
    v_add_f32_dpp v24, v24, v24 row_mirror row_mask:0xf bank_mask:0xf
    v_mul_f32 v20, 0x3b124925, v20
    v_mul_f32 v24, 0x3b124925, v24
    v_fma_f32 v24, -v20, v20, v24
    v_max_f32 v24, 0, v24
    v_add_f32 v24, 0x3727c5ac, v24
    v_rsq_f32 v22, v24
    v_add_u32 v26, 12, v30
    v_mul_u32_u24 v26, 112, v26
    v_add_u32 v26, s20, v26
    v_bfe_u32 v27, v26, 1, 2
    v_lshlrev_b32 v27, 12, v27
    v_lshrrev_b32 v28, 3, v26
    v_lshl_add_u32 v27, v28, 4, v27
    v_and_b32 v28, 1, v26
    v_lshl_add_u32 v27, v28, 3, v27
    v_mov_b32 v28, 0x40000000
    v_cmp_gt_u32 vcc, 2048, v26
    v_mul_f32 v23, v20, v22
    s_mov_b32 s23, 0
    v_cndmask_b32 v27, v28, v27, vcc
    s_mov_b32 s28, 0x00010001
    s_mov_b32 s29, 0x00010001
    s_mov_b64 exec, s[28:29]
    buffer_store_dwordx2 v[22:23], v27, s[8:11], s23 offen sc1
    s_mov_b64 exec, -1
    s_waitcnt vmcnt(4)
    v_mov_b32 v20, 0
    v_mov_b32 v21, 0
    v_mov_b32 v22, 0
    v_mov_b32 v23, 0
    v_mov_b32 v24, 0
    v_mov_b32 v25, 0
    v_mov_b32 v26, 0
    v_mov_b32 v27, 0
    v_dot2c_f32_bf16 v20, s71, v164
    v_dot2c_f32_bf16 v24, v164, v164
    v_dot2c_f32_bf16 v21, s71, v168
    v_dot2c_f32_bf16 v25, v168, v168
    v_dot2c_f32_bf16 v22, s71, v172
    v_dot2c_f32_bf16 v26, v172, v172
    v_dot2c_f32_bf16 v23, s71, v176
    v_dot2c_f32_bf16 v27, v176, v176
    v_dot2c_f32_bf16 v20, s71, v165
    v_dot2c_f32_bf16 v24, v165, v165
    v_dot2c_f32_bf16 v21, s71, v169
    v_dot2c_f32_bf16 v25, v169, v169
    v_dot2c_f32_bf16 v22, s71, v173
    v_dot2c_f32_bf16 v26, v173, v173
    v_dot2c_f32_bf16 v23, s71, v177
    v_dot2c_f32_bf16 v27, v177, v177
    v_dot2c_f32_bf16 v20, s71, v166
    v_dot2c_f32_bf16 v24, v166, v166
    v_dot2c_f32_bf16 v21, s71, v170
    v_dot2c_f32_bf16 v25, v170, v170
    v_dot2c_f32_bf16 v22, s71, v174
    v_dot2c_f32_bf16 v26, v174, v174
    v_dot2c_f32_bf16 v23, s71, v178
    v_dot2c_f32_bf16 v27, v178, v178
    v_dot2c_f32_bf16 v20, s71, v167
    v_dot2c_f32_bf16 v24, v167, v167
    v_dot2c_f32_bf16 v21, s71, v171
    v_dot2c_f32_bf16 v25, v171, v171
    v_dot2c_f32_bf16 v22, s71, v175
    v_dot2c_f32_bf16 v26, v175, v175
    v_dot2c_f32_bf16 v23, s71, v179
    v_dot2c_f32_bf16 v27, v179, v179
    v_permlane32_swap_b32 v20, v22
    s_nop 0
    v_permlane32_swap_b32 v21, v23
    v_permlane32_swap_b32 v24, v26
    v_permlane32_swap_b32 v25, v27
    v_add_f32 v20, v20, v22
    v_add_f32 v21, v21, v23
    v_add_f32 v24, v24, v26
    v_add_f32 v25, v25, v27
    v_permlane16_swap_b32 v20, v21
    s_nop 0
    v_permlane16_swap_b32 v24, v25
    v_add_f32 v20, v20, v21
    v_add_f32 v24, v24, v25
    s_nop 0
    v_add_f32_dpp v20, v20, v20 quad_perm:[1,0,3,2] row_mask:0xf bank_mask:0xf
    v_add_f32_dpp v24, v24, v24 quad_perm:[1,0,3,2] row_mask:0xf bank_mask:0xf
    s_nop 0
    v_add_f32_dpp v20, v20, v20 quad_perm:[2,3,0,1] row_mask:0xf bank_mask:0xf
    v_add_f32_dpp v24, v24, v24 quad_perm:[2,3,0,1] row_mask:0xf bank_mask:0xf
    s_nop 0
    v_add_f32_dpp v20, v20, v20 row_half_mirror row_mask:0xf bank_mask:0xf
    v_add_f32_dpp v24, v24, v24 row_half_mirror row_mask:0xf bank_mask:0xf
    s_nop 0
    v_add_f32_dpp v20, v20, v20 row_mirror row_mask:0xf bank_mask:0xf
    v_add_f32_dpp v24, v24, v24 row_mirror row_mask:0xf bank_mask:0xf
    v_mul_f32 v20, 0x3b124925, v20
    v_mul_f32 v24, 0x3b124925, v24
    v_fma_f32 v24, -v20, v20, v24
    v_max_f32 v24, 0, v24
    v_add_f32 v24, 0x3727c5ac, v24
    v_rsq_f32 v22, v24
    v_add_u32 v26, 16, v30
    v_mul_u32_u24 v26, 112, v26
    v_add_u32 v26, s20, v26
    v_bfe_u32 v27, v26, 1, 2
    v_lshlrev_b32 v27, 12, v27
    v_lshrrev_b32 v28, 3, v26
    v_lshl_add_u32 v27, v28, 4, v27
    v_and_b32 v28, 1, v26
    v_lshl_add_u32 v27, v28, 3, v27
    v_mov_b32 v28, 0x40000000
    v_cmp_gt_u32 vcc, 2048, v26
    v_mul_f32 v23, v20, v22
    s_mov_b32 s23, 0
    v_cndmask_b32 v27, v28, v27, vcc
    s_mov_b32 s28, 0x00010001
    s_mov_b32 s29, 0x00010001
    s_mov_b64 exec, s[28:29]
    buffer_store_dwordx2 v[22:23], v27, s[8:11], s23 offen sc1
    s_mov_b64 exec, -1
    s_waitcnt vmcnt(0)
    s_barrier
    s_cmp_eq_u32 s64, 0
    s_cbranch_scc0 L_h_noA
    s_mov_b64 exec, 1
    v_mov_b32 v16, 0
    v_mov_b32 v17, 1
    global_atomic_add v16, v17, s[60:61]
    s_mov_b64 exec, -1
L_h_noA:
    s_lshl_b32 s20, s2, 2
    s_add_u32 s20, s20, s64
    v_lshrrev_b32 v2, 2, v1
    v_and_b32 v3, 3, v1
    v_mul_u32_u24 v7, 896, v2
    v_lshl_add_u32 v7, v3, 4, v7
    s_mul_i32 s25, s64, 40960
    s_lshr_b32 s21, s20, 4
    s_bfe_u32 s22, s20, 0x20002
    s_bfe_u32 s23, s20, 0x10001
    s_and_b32 s24, s20, 1
    s_mul_i32 s26, s22, 448
    s_mul_i32 s27, s24, 224
    s_add_u32 s26, s26, s27
    s_mul_i32 s26, s26, 896
    s_lshl_b32 s27, s21, 7
    s_add_u32 s26, s26, s27
    s_lshl_b32 s27, s23, 6
    s_add_u32 s26, s26, s27
    v_and_b32 v201, 15, v1
    v_lshlrev_b32 v201, 21, v201
    global_load_dword v208, v201, s[62:63]
    v_mov_b32 v202, 0
    global_load_dword v209, v202, s[58:59]
    global_load_dword v210, v202, s[52:53]
    global_load_dword v211, v202, s[54:55]
    global_load_dword v213, v202, s[60:61]
    s_mov_b32 s4, s56
    s_and_b32 s5, s57, 0xffff
    s_mov_b32 s6, 1605632
    s_mov_b32 s7, 0x20000
    s_add_u32 s27, s26, 0
    s_add_u32 m0, s25, 0
    s_nop 0
    buffer_load_dwordx4 v7, s[4:7], s27 offen lds
    s_add_u32 s27, s26, 14336
    s_add_u32 m0, s25, 1024
    s_nop 0
    buffer_load_dwordx4 v7, s[4:7], s27 offen lds
    s_add_u32 s27, s26, 28672
    s_add_u32 m0, s25, 2048
    s_nop 0
    buffer_load_dwordx4 v7, s[4:7], s27 offen lds
    s_add_u32 s27, s26, 43008
    s_add_u32 m0, s25, 3072
    s_nop 0
    buffer_load_dwordx4 v7, s[4:7], s27 offen lds
    s_add_u32 s27, s26, 57344
    s_add_u32 m0, s25, 4096
    s_nop 0
    buffer_load_dwordx4 v7, s[4:7], s27 offen lds
    s_add_u32 s27, s26, 71680
    s_add_u32 m0, s25, 5120
    s_nop 0
    buffer_load_dwordx4 v7, s[4:7], s27 offen lds
    s_add_u32 s27, s26, 86016
    s_add_u32 m0, s25, 6144
    s_nop 0
    buffer_load_dwordx4 v7, s[4:7], s27 offen lds
    s_add_u32 s27, s26, 100352
    s_add_u32 m0, s25, 7168
    s_nop 0
    buffer_load_dwordx4 v7, s[4:7], s27 offen lds
    s_add_u32 s27, s26, 114688
    s_add_u32 m0, s25, 8192
    s_nop 0
    buffer_load_dwordx4 v7, s[4:7], s27 offen lds
    s_add_u32 s27, s26, 129024
    s_add_u32 m0, s25, 9216
    s_nop 0
    buffer_load_dwordx4 v7, s[4:7], s27 offen lds
    s_add_u32 s27, s26, 143360
    s_add_u32 m0, s25, 10240
    s_nop 0
    buffer_load_dwordx4 v7, s[4:7], s27 offen lds
    s_add_u32 s27, s26, 157696
    s_add_u32 m0, s25, 11264
    s_nop 0
    buffer_load_dwordx4 v7, s[4:7], s27 offen lds
    s_add_u32 s27, s26, 172032
    s_add_u32 m0, s25, 12288
    s_nop 0
    buffer_load_dwordx4 v7, s[4:7], s27 offen lds
    s_add_u32 s27, s26, 186368
    s_add_u32 m0, s25, 13312
    s_nop 0
    buffer_load_dwordx4 v7, s[4:7], s27 offen lds
    v_lshrrev_b32 v3, 4, v1
    v_and_b32 v4, 15, v1
    v_lshrrev_b32 v8, 2, v4
    v_lshrrev_b32 v9, 1, v3
    v_and_b32 v10, 1, v3
    v_lshlrev_b32 v10, 5, v10
    v_and_b32 v11, 3, v4
    v_lshl_add_u32 v10, v11, 3, v10
    v_add_u32 v10, s25, v10
    v_lshl_add_u32 v11, v9, 2, v8
    v_lshl_add_u32 v13, v11, 6, v10
    v_lshlrev_b32 v14, 4, v1
    s_lshl_b32 s26, s21, 2
    s_add_u32 s26, s26, s22
    s_mul_i32 s26, s26, 56
    s_mul_i32 s27, s24, 28
    s_add_u32 s26, s26, s27
    s_add_u32 s26, s26, s23
    s_lshl_b32 s26, s26, 10
    s_add_u32 s26, s26, 18350080
    s_mov_b32 s8, s62
    s_and_b32 s9, s63, 0xffff
    s_mov_b32 s10, 33554432
    s_mov_b32 s11, 0x20000
    s_waitcnt vmcnt(0)
    ds_read_b64_tr_b16 v[16:17], v13 offset:0
    ds_read_b64_tr_b16 v[18:19], v13 offset:512
    ds_read_b64_tr_b16 v[20:21], v13 offset:1024
    ds_read_b64_tr_b16 v[22:23], v13 offset:1536
    ds_read_b64_tr_b16 v[24:25], v13 offset:2048
    ds_read_b64_tr_b16 v[26:27], v13 offset:2560
    ds_read_b64_tr_b16 v[28:29], v13 offset:3072
    ds_read_b64_tr_b16 v[30:31], v13 offset:3584
    ds_read_b64_tr_b16 v[32:33], v13 offset:4096
    ds_read_b64_tr_b16 v[34:35], v13 offset:4608
    ds_read_b64_tr_b16 v[36:37], v13 offset:5120
    ds_read_b64_tr_b16 v[38:39], v13 offset:5632
    s_waitcnt lgkmcnt(4)
    ds_read_b64_tr_b16 v[40:41], v13 offset:6144
    ds_read_b64_tr_b16 v[42:43], v13 offset:6656
    ds_read_b64_tr_b16 v[44:45], v13 offset:7168
    ds_read_b64_tr_b16 v[46:47], v13 offset:7680
    ds_read_b64_tr_b16 v[48:49], v13 offset:8192
    ds_read_b64_tr_b16 v[50:51], v13 offset:8704
    ds_read_b64_tr_b16 v[52:53], v13 offset:9216
    ds_read_b64_tr_b16 v[54:55], v13 offset:9728
    ds_read_b64_tr_b16 v[56:57], v13 offset:10240
    ds_read_b64_tr_b16 v[58:59], v13 offset:10752
    s_waitcnt lgkmcnt(4)
    ds_read_b64_tr_b16 v[60:61], v13 offset:11264
    ds_read_b64_tr_b16 v[62:63], v13 offset:11776
    ds_read_b64_tr_b16 v[64:65], v13 offset:12288
    ds_read_b64_tr_b16 v[66:67], v13 offset:12800
    ds_read_b64_tr_b16 v[68:69], v13 offset:13312
    ds_read_b64_tr_b16 v[70:71], v13 offset:13824
    s_waitcnt lgkmcnt(0)
    s_add_u32 s21, s26, 0
    buffer_store_dwordx4 v[16:19], v14, s[8:11], s21 offen sc1
    s_add_u32 s21, s26, 2048
    buffer_store_dwordx4 v[20:23], v14, s[8:11], s21 offen sc1
    s_add_u32 s21, s26, 4096
    buffer_store_dwordx4 v[24:27], v14, s[8:11], s21 offen sc1
    s_add_u32 s21, s26, 6144
    buffer_store_dwordx4 v[28:31], v14, s[8:11], s21 offen sc1
    s_add_u32 s21, s26, 8192
    buffer_store_dwordx4 v[32:35], v14, s[8:11], s21 offen sc1
    s_add_u32 s21, s26, 10240
    buffer_store_dwordx4 v[36:39], v14, s[8:11], s21 offen sc1
    s_add_u32 s21, s26, 12288
    buffer_store_dwordx4 v[40:43], v14, s[8:11], s21 offen sc1
    s_add_u32 s21, s26, 14336
    buffer_store_dwordx4 v[44:47], v14, s[8:11], s21 offen sc1
    s_add_u32 s21, s26, 16384
    buffer_store_dwordx4 v[48:51], v14, s[8:11], s21 offen sc1
    s_add_u32 s21, s26, 18432
    buffer_store_dwordx4 v[52:55], v14, s[8:11], s21 offen sc1
    s_add_u32 s21, s26, 20480
    buffer_store_dwordx4 v[56:59], v14, s[8:11], s21 offen sc1
    s_add_u32 s21, s26, 22528
    buffer_store_dwordx4 v[60:63], v14, s[8:11], s21 offen sc1
    s_add_u32 s21, s26, 24576
    buffer_store_dwordx4 v[64:67], v14, s[8:11], s21 offen sc1
    s_add_u32 s21, s26, 26624
    buffer_store_dwordx4 v[68:71], v14, s[8:11], s21 offen sc1
    s_waitcnt vmcnt(0)
    s_barrier
    s_cmp_eq_u32 s64, 0
    s_cbranch_scc0 L_h_nosig
    s_mov_b64 exec, 1
    v_mov_b32 v2, 128
    v_mov_b32 v3, 1
    global_atomic_add v2, v3, s[60:61]
    s_mov_b64 exec, -1
L_h_nosig:
    s_cmp_eq_u32 s64, 0
    s_cbranch_scc0 L_end
L_end:
    s_endpgm
.p2align 6
L_idxtab:
.short 0, 0, 128, 256, 384, 512, 640, 768, 896, 0, 0, 0, 0, 0, 0, 0
.short 896, 4, 132, 260, 388, 516, 644, 772, 900, 0, 0, 0, 0, 0, 0, 0
.short 900, 8, 136, 264, 392, 520, 648, 776, 904, 0, 0, 0, 0, 0, 0, 0
.short 904, 12, 140, 268, 396, 524, 652, 780, 908, 0, 0, 0, 0, 0, 0, 0
.short 908, 16, 144, 272, 400, 528, 656, 784, 912, 0, 0, 0, 0, 0, 0, 0
.short 912, 20, 148, 276, 404, 532, 660, 788, 916, 0, 0, 0, 0, 0, 0, 0
.short 916, 24, 152, 280, 408, 536, 664, 792, 920, 0, 0, 0, 0, 0, 0, 0
.short 920, 28, 156, 284, 412, 540, 668, 796, 924, 0, 0, 0, 0, 0, 0, 0
.short 924, 32, 160, 288, 416, 544, 672, 800, 928, 0, 0, 0, 0, 0, 0, 0
.short 928, 36, 164, 292, 420, 548, 676, 804, 932, 0, 0, 0, 0, 0, 0, 0
.short 932, 40, 168, 296, 424, 552, 680, 808, 936, 0, 0, 0, 0, 0, 0, 0
.short 936, 44, 172, 300, 428, 556, 684, 812, 940, 0, 0, 0, 0, 0, 0, 0
.short 940, 48, 176, 304, 432, 560, 688, 816, 944, 0, 0, 0, 0, 0, 0, 0
.short 944, 52, 180, 308, 436, 564, 692, 820, 948, 0, 0, 0, 0, 0, 0, 0
.short 948, 56, 184, 312, 440, 568, 696, 824, 952, 0, 0, 0, 0, 0, 0, 0
.short 952, 60, 188, 316, 444, 572, 700, 828, 956, 0, 0, 0, 0, 0, 0, 0
.short 956, 64, 192, 320, 448, 576, 704, 832, 960, 0, 0, 0, 0, 0, 0, 0
.short 960, 68, 196, 324, 452, 580, 708, 836, 964, 0, 0, 0, 0, 0, 0, 0
.short 964, 72, 200, 328, 456, 584, 712, 840, 968, 0, 0, 0, 0, 0, 0, 0
.short 968, 76, 204, 332, 460, 588, 716, 844, 972, 0, 0, 0, 0, 0, 0, 0
.short 972, 80, 208, 336, 464, 592, 720, 848, 976, 0, 0, 0, 0, 0, 0, 0
.short 976, 84, 212, 340, 468, 596, 724, 852, 980, 0, 0, 0, 0, 0, 0, 0
.short 980, 88, 216, 344, 472, 600, 728, 856, 984, 0, 0, 0, 0, 0, 0, 0
.short 984, 92, 220, 348, 476, 604, 732, 860, 988, 0, 0, 0, 0, 0, 0, 0
.short 988, 96, 224, 352, 480, 608, 736, 864, 992, 0, 0, 0, 0, 0, 0, 0
.short 992, 100, 228, 356, 484, 612, 740, 868, 996, 0, 0, 0, 0, 0, 0, 0
.short 996, 104, 232, 360, 488, 616, 744, 872, 1000, 0, 0, 0, 0, 0, 0, 0
.short 1000, 108, 236, 364, 492, 620, 748, 876, 1004, 0, 0, 0, 0, 0, 0, 0
.short 1004, 112, 240, 368, 496, 624, 752, 880, 1008, 0, 0, 0, 0, 0, 0, 0
.short 1008, 116, 244, 372, 500, 628, 756, 884, 1012, 0, 0, 0, 0, 0, 0, 0
.short 1012, 120, 248, 376, 504, 632, 760, 888, 1016, 0, 0, 0, 0, 0, 0, 0
.short 1016, 124, 252, 380, 508, 636, 764, 892, 1020, 0, 0, 0, 0, 0, 0, 0
.short 1020, 1024, 1024, 1152, 1280, 1280, 1280, 1408, 1028, 0, 0, 0, 0, 0, 0, 0
.short 1028, 1028, 1028, 1156, 1284, 1284, 1284, 1412, 1032, 0, 0, 0, 0, 0, 0, 0
.short 1032, 1032, 1032, 1160, 1288, 1288, 1288, 1416, 1036, 0, 0, 0, 0, 0, 0, 0
.short 1036, 1036, 1036, 1164, 1292, 1292, 1292, 1420, 1040, 0, 0, 0, 0, 0, 0, 0
.short 1040, 1040, 1040, 1168, 1296, 1296, 1296, 1424, 1044, 0, 0, 0, 0, 0, 0, 0
.short 1044, 1044, 1044, 1172, 1300, 1300, 1300, 1428, 1048, 0, 0, 0, 0, 0, 0, 0
.short 1048, 1048, 1048, 1176, 1304, 1304, 1304, 1432, 1052, 0, 0, 0, 0, 0, 0, 0
.short 1052, 1052, 1052, 1180, 1308, 1308, 1308, 1436, 1056, 0, 0, 0, 0, 0, 0, 0
.short 1056, 1056, 1056, 1184, 1312, 1312, 1312, 1440, 1060, 0, 0, 0, 0, 0, 0, 0
.short 1060, 1060, 1060, 1188, 1316, 1316, 1316, 1444, 1064, 0, 0, 0, 0, 0, 0, 0
.short 1064, 1064, 1064, 1192, 1320, 1320, 1320, 1448, 1068, 0, 0, 0, 0, 0, 0, 0
.short 1068, 1068, 1068, 1196, 1324, 1324, 1324, 1452, 1072, 0, 0, 0, 0, 0, 0, 0
.short 1072, 1072, 1072, 1200, 1328, 1328, 1328, 1456, 1076, 0, 0, 0, 0, 0, 0, 0
.short 1076, 1076, 1076, 1204, 1332, 1332, 1332, 1460, 1080, 0, 0, 0, 0, 0, 0, 0
.short 1080, 1080, 1080, 1208, 1336, 1336, 1336, 1464, 1084, 0, 0, 0, 0, 0, 0, 0
.short 1084, 1084, 1084, 1212, 1340, 1340, 1340, 1468, 1088, 0, 0, 0, 0, 0, 0, 0
.short 1088, 1088, 1088, 1216, 1344, 1344, 1344, 1472, 1092, 0, 0, 0, 0, 0, 0, 0
.short 1092, 1092, 1092, 1220, 1348, 1348, 1348, 1476, 1096, 0, 0, 0, 0, 0, 0, 0
.short 1096, 1096, 1096, 1224, 1352, 1352, 1352, 1480, 1100, 0, 0, 0, 0, 0, 0, 0
.short 1100, 1100, 1100, 1228, 1356, 1356, 1356, 1484, 1104, 0, 0, 0, 0, 0, 0, 0
.short 1104, 1104, 1104, 1232, 1360, 1360, 1360, 1488, 1108, 0, 0, 0, 0, 0, 0, 0
.short 1108, 1108, 1108, 1236, 1364, 1364, 1364, 1492, 1112, 0, 0, 0, 0, 0, 0, 0
.short 1112, 1112, 1112, 1240, 1368, 1368, 1368, 1496, 1116, 0, 0, 0, 0, 0, 0, 0
.short 1116, 1116, 1116, 1244, 1372, 1372, 1372, 1500, 1120, 0, 0, 0, 0, 0, 0, 0
.short 1120, 1120, 1120, 1248, 1376, 1376, 1376, 1504, 1124, 0, 0, 0, 0, 0, 0, 0
.short 1124, 1124, 1124, 1252, 1380, 1380, 1380, 1508, 1128, 0, 0, 0, 0, 0, 0, 0
.short 1128, 1128, 1128, 1256, 1384, 1384, 1384, 1512, 1132, 0, 0, 0, 0, 0, 0, 0
.short 1132, 1132, 1132, 1260, 1388, 1388, 1388, 1516, 1136, 0, 0, 0, 0, 0, 0, 0
.short 1136, 1136, 1136, 1264, 1392, 1392, 1392, 1520, 1140, 0, 0, 0, 0, 0, 0, 0
.short 1140, 1140, 1140, 1268, 1396, 1396, 1396, 1524, 1144, 0, 0, 0, 0, 0, 0, 0
.short 1144, 1144, 1144, 1272, 1400, 1400, 1400, 1528, 1148, 0, 0, 0, 0, 0, 0, 0
.short 1148, 1148, 1148, 1276, 1404, 1404, 1404, 1532, 1536, 0, 0, 0, 0, 0, 0, 0
.short 1536, 1536, 1536, 1536, 1664, 1664, 1664, 1540, 1540, 0, 0, 0, 0, 0, 0, 0
.short 1540, 1540, 1540, 1540, 1668, 1668, 1668, 1544, 1544, 0, 0, 0, 0, 0, 0, 0
.short 1544, 1544, 1544, 1544, 1672, 1672, 1672, 1548, 1548, 0, 0, 0, 0, 0, 0, 0
.short 1548, 1548, 1548, 1548, 1676, 1676, 1676, 1552, 1552, 0, 0, 0, 0, 0, 0, 0
.short 1552, 1552, 1552, 1552, 1680, 1680, 1680, 1556, 1556, 0, 0, 0, 0, 0, 0, 0
.short 1556, 1556, 1556, 1556, 1684, 1684, 1684, 1560, 1560, 0, 0, 0, 0, 0, 0, 0
.short 1560, 1560, 1560, 1560, 1688, 1688, 1688, 1564, 1564, 0, 0, 0, 0, 0, 0, 0
.short 1564, 1564, 1564, 1564, 1692, 1692, 1692, 1568, 1568, 0, 0, 0, 0, 0, 0, 0
.short 1568, 1568, 1568, 1568, 1696, 1696, 1696, 1572, 1572, 0, 0, 0, 0, 0, 0, 0
.short 1572, 1572, 1572, 1572, 1700, 1700, 1700, 1576, 1576, 0, 0, 0, 0, 0, 0, 0
.short 1576, 1576, 1576, 1576, 1704, 1704, 1704, 1580, 1580, 0, 0, 0, 0, 0, 0, 0
.short 1580, 1580, 1580, 1580, 1708, 1708, 1708, 1584, 1584, 0, 0, 0, 0, 0, 0, 0
.short 1584, 1584, 1584, 1584, 1712, 1712, 1712, 1588, 1588, 0, 0, 0, 0, 0, 0, 0
.short 1588, 1588, 1588, 1588, 1716, 1716, 1716, 1592, 1592, 0, 0, 0, 0, 0, 0, 0
.short 1592, 1592, 1592, 1592, 1720, 1720, 1720, 1596, 1596, 0, 0, 0, 0, 0, 0, 0
.short 1596, 1596, 1596, 1596, 1724, 1724, 1724, 1600, 1600, 0, 0, 0, 0, 0, 0, 0
.short 1600, 1600, 1600, 1600, 1728, 1728, 1728, 1604, 1604, 0, 0, 0, 0, 0, 0, 0
.short 1604, 1604, 1604, 1604, 1732, 1732, 1732, 1608, 1608, 0, 0, 0, 0, 0, 0, 0
.short 1608, 1608, 1608, 1608, 1736, 1736, 1736, 1612, 1612, 0, 0, 0, 0, 0, 0, 0
.short 1612, 1612, 1612, 1612, 1740, 1740, 1740, 1616, 1616, 0, 0, 0, 0, 0, 0, 0
.short 1616, 1616, 1616, 1616, 1744, 1744, 1744, 1620, 1620, 0, 0, 0, 0, 0, 0, 0
.short 1620, 1620, 1620, 1620, 1748, 1748, 1748, 1624, 1624, 0, 0, 0, 0, 0, 0, 0
.short 1624, 1624, 1624, 1624, 1752, 1752, 1752, 1628, 1628, 0, 0, 0, 0, 0, 0, 0
.short 1628, 1628, 1628, 1628, 1756, 1756, 1756, 1632, 1632, 0, 0, 0, 0, 0, 0, 0
.short 1632, 1632, 1632, 1632, 1760, 1760, 1760, 1636, 1636, 0, 0, 0, 0, 0, 0, 0
.short 1636, 1636, 1636, 1636, 1764, 1764, 1764, 1640, 1640, 0, 0, 0, 0, 0, 0, 0
.short 1640, 1640, 1640, 1640, 1768, 1768, 1768, 1644, 1644, 0, 0, 0, 0, 0, 0, 0
.short 1644, 1644, 1644, 1644, 1772, 1772, 1772, 1648, 1648, 0, 0, 0, 0, 0, 0, 0
.short 1648, 1648, 1648, 1648, 1776, 1776, 1776, 1652, 1652, 0, 0, 0, 0, 0, 0, 0
.short 1652, 1652, 1652, 1652, 1780, 1780, 1780, 1656, 1656, 0, 0, 0, 0, 0, 0, 0
.short 1656, 1656, 1656, 1656, 1784, 1784, 1784, 1660, 1660, 0, 0, 0, 0, 0, 0, 0
.short 1660, 1660, 1660, 1660, 1788, 1788, 1788, 1792, 1792, 0, 0, 0, 0, 0, 0, 0
.short 1792, 1792, 1792, 1792, 1920, 1920, 1920, 1796, 1796, 0, 0, 0, 0, 0, 0, 0
.short 1796, 1796, 1796, 1796, 1924, 1924, 1924, 1800, 1800, 0, 0, 0, 0, 0, 0, 0
.short 1800, 1800, 1800, 1800, 1928, 1928, 1928, 1804, 1804, 0, 0, 0, 0, 0, 0, 0
.short 1804, 1804, 1804, 1804, 1932, 1932, 1932, 1808, 1808, 0, 0, 0, 0, 0, 0, 0
.short 1808, 1808, 1808, 1808, 1936, 1936, 1936, 1812, 1812, 0, 0, 0, 0, 0, 0, 0
.short 1812, 1812, 1812, 1812, 1940, 1940, 1940, 1816, 1816, 0, 0, 0, 0, 0, 0, 0
.short 1816, 1816, 1816, 1816, 1944, 1944, 1944, 1820, 1820, 0, 0, 0, 0, 0, 0, 0
.short 1820, 1820, 1820, 1820, 1948, 1948, 1948, 1824, 1824, 0, 0, 0, 0, 0, 0, 0
.short 1824, 1824, 1824, 1824, 1952, 1952, 1952, 1828, 1828, 0, 0, 0, 0, 0, 0, 0
.short 1828, 1828, 1828, 1828, 1956, 1956, 1956, 1832, 1832, 0, 0, 0, 0, 0, 0, 0
.short 1832, 1832, 1832, 1832, 1960, 1960, 1960, 1836, 1836, 0, 0, 0, 0, 0, 0, 0
.short 1836, 1836, 1836, 1836, 1964, 1964, 1964, 1840, 1840, 0, 0, 0, 0, 0, 0, 0
.short 1840, 1840, 1840, 1840, 1968, 1968, 1968, 1844, 1844, 0, 0, 0, 0, 0, 0, 0
.short 1844, 1844, 1844, 1844, 1972, 1972, 1972, 1848, 1848, 0, 0, 0, 0, 0, 0, 0
.short 1848, 1848, 1848, 1848, 1976, 1976, 1976, 1852, 1852, 0, 0, 0, 0, 0, 0, 0
.short 1852, 1852, 1852, 1852, 1980, 1980, 1980, 1856, 1856, 0, 0, 0, 0, 0, 0, 0
.short 1856, 1856, 1856, 1856, 1984, 1984, 1984, 1860, 1860, 0, 0, 0, 0, 0, 0, 0
.short 1860, 1860, 1860, 1860, 1988, 1988, 1988, 1864, 1864, 0, 0, 0, 0, 0, 0, 0
.short 1864, 1864, 1864, 1864, 1992, 1992, 1992, 1868, 1868, 0, 0, 0, 0, 0, 0, 0
.short 1868, 1868, 1868, 1868, 1996, 1996, 1996, 1872, 1872, 0, 0, 0, 0, 0, 0, 0
.short 1872, 1872, 1872, 1872, 2000, 2000, 2000, 1876, 1876, 0, 0, 0, 0, 0, 0, 0
.short 1876, 1876, 1876, 1876, 2004, 2004, 2004, 1880, 1880, 0, 0, 0, 0, 0, 0, 0
.short 1880, 1880, 1880, 1880, 2008, 2008, 2008, 1884, 1884, 0, 0, 0, 0, 0, 0, 0
.short 1884, 1884, 1884, 1884, 2012, 2012, 2012, 1888, 1888, 0, 0, 0, 0, 0, 0, 0
.short 1888, 1888, 1888, 1888, 2016, 2016, 2016, 1892, 1892, 0, 0, 0, 0, 0, 0, 0
.short 1892, 1892, 1892, 1892, 2020, 2020, 2020, 1896, 1896, 0, 0, 0, 0, 0, 0, 0
.short 1896, 1896, 1896, 1896, 2024, 2024, 2024, 1900, 1900, 0, 0, 0, 0, 0, 0, 0
.short 1900, 1900, 1900, 1900, 2028, 2028, 2028, 1904, 1904, 0, 0, 0, 0, 0, 0, 0
.short 1904, 1904, 1904, 1904, 2032, 2032, 2032, 1908, 1908, 0, 0, 0, 0, 0, 0, 0
.short 1908, 1908, 1908, 1908, 2036, 2036, 2036, 1912, 1912, 0, 0, 0, 0, 0, 0, 0
.short 1912, 1912, 1912, 1912, 2040, 2040, 2040, 1916, 1916, 0, 0, 0, 0, 0, 0, 0
.short 1916, 1916, 1916, 1916, 2044, 2044, 2044, 2048, 2048, 0, 0, 0, 0, 0, 0, 0
.short 2048, 2048, 2048, 2048, 2048, 2048, 2052, 2052, 2052, 0, 0, 0, 0, 0, 0, 0
.short 2052, 2052, 2052, 2052, 2052, 2056, 2056, 2056, 2056, 0, 0, 0, 0, 0, 0, 0
.short 2056, 2056, 2056, 2056, 2056, 2056, 2060, 2060, 2060, 0, 0, 0, 0, 0, 0, 0
.short 2060, 2060, 2060, 2060, 2060, 2064, 2064, 2064, 2064, 0, 0, 0, 0, 0, 0, 0
.short 2064, 2064, 2064, 2064, 2064, 2064, 2068, 2068, 2068, 0, 0, 0, 0, 0, 0, 0
.short 2068, 2068, 2068, 2068, 2068, 2072, 2072, 2072, 2072, 0, 0, 0, 0, 0, 0, 0
.short 2072, 2072, 2072, 2072, 2072, 2072, 2076, 2076, 2076, 0, 0, 0, 0, 0, 0, 0
.short 2076, 2076, 2076, 2076, 2076, 2080, 2080, 2080, 2080, 0, 0, 0, 0, 0, 0, 0
.short 2080, 2080, 2080, 2080, 2080, 2080, 2084, 2084, 2084, 0, 0, 0, 0, 0, 0, 0
.short 2084, 2084, 2084, 2084, 2084, 2088, 2088, 2088, 2088, 0, 0, 0, 0, 0, 0, 0
.short 2088, 2088, 2088, 2088, 2088, 2088, 2092, 2092, 2092, 0, 0, 0, 0, 0, 0, 0
.short 2092, 2092, 2092, 2092, 2092, 2096, 2096, 2096, 2096, 0, 0, 0, 0, 0, 0, 0
.short 2096, 2096, 2096, 2096, 2096, 2096, 2100, 2100, 2100, 0, 0, 0, 0, 0, 0, 0
.short 2100, 2100, 2100, 2100, 2100, 2104, 2104, 2104, 2104, 0, 0, 0, 0, 0, 0, 0
.short 2104, 2104, 2104, 2104, 2104, 2104, 2108, 2108, 2108, 0, 0, 0, 0, 0, 0, 0
.short 2108, 2108, 2108, 2108, 2108, 2112, 2112, 2112, 2112, 0, 0, 0, 0, 0, 0, 0
.short 2112, 2112, 2112, 2112, 2112, 2112, 2116, 2116, 2116, 0, 0, 0, 0, 0, 0, 0
.short 2116, 2116, 2116, 2116, 2116, 2120, 2120, 2120, 2120, 0, 0, 0, 0, 0, 0, 0
.short 2120, 2120, 2120, 2120, 2120, 2120, 2124, 2124, 2124, 0, 0, 0, 0, 0, 0, 0
.short 2124, 2124, 2124, 2124, 2124, 2128, 2128, 2128, 2128, 0, 0, 0, 0, 0, 0, 0
.short 2128, 2128, 2128, 2128, 2128, 2128, 2132, 2132, 2132, 0, 0, 0, 0, 0, 0, 0
.short 2132, 2132, 2132, 2132, 2132, 2136, 2136, 2136, 2136, 0, 0, 0, 0, 0, 0, 0
.short 2136, 2136, 2136, 2136, 2136, 2136, 2140, 2140, 2140, 0, 0, 0, 0, 0, 0, 0
.short 2140, 2140, 2140, 2140, 2140, 2144, 2144, 2144, 2144, 0, 0, 0, 0, 0, 0, 0
.short 2144, 2144, 2144, 2144, 2144, 2144, 2148, 2148, 2148, 0, 0, 0, 0, 0, 0, 0
.short 2148, 2148, 2148, 2148, 2148, 2152, 2152, 2152, 2152, 0, 0, 0, 0, 0, 0, 0
.short 2152, 2152, 2152, 2152, 2152, 2152, 2156, 2156, 2156, 0, 0, 0, 0, 0, 0, 0
.short 2156, 2156, 2156, 2156, 2156, 2160, 2160, 2160, 2160, 0, 0, 0, 0, 0, 0, 0
.short 2160, 2160, 2160, 2160, 2160, 2160, 2164, 2164, 2164, 0, 0, 0, 0, 0, 0, 0
.short 2164, 2164, 2164, 2164, 2164, 2168, 2168, 2168, 2168, 0, 0, 0, 0, 0, 0, 0
.short 2168, 2168, 2168, 2168, 2168, 2168, 2172, 2172, 2172, 0, 0, 0, 0, 0, 0, 0
.short 2172, 2172, 2172, 2172, 2172, 2176, 2176, 2176, 2176, 0, 0, 0, 0, 0, 0, 0
.short 2176, 2176, 2176, 2176, 2176, 2176, 2180, 2180, 2180, 0, 0, 0, 0, 0, 0, 0
.short 2180, 2180, 2180, 2180, 2180, 2184, 2184, 2184, 2184, 0, 0, 0, 0, 0, 0, 0
.short 2184, 2184, 2184, 2184, 2184, 2184, 2188, 2188, 2188, 0, 0, 0, 0, 0, 0, 0
.short 2188, 2188, 2188, 2188, 2188, 2192, 2192, 2192, 2192, 0, 0, 0, 0, 0, 0, 0
.short 2192, 2192, 2192, 2192, 2192, 2192, 2196, 2196, 2196, 0, 0, 0, 0, 0, 0, 0
.short 2196, 2196, 2196, 2196, 2196, 2200, 2200, 2200, 2200, 0, 0, 0, 0, 0, 0, 0
.short 2200, 2200, 2200, 2200, 2200, 2200, 2204, 2204, 2204, 0, 0, 0, 0, 0, 0, 0
.short 2204, 2204, 2204, 2204, 2204, 2208, 2208, 2208, 2208, 0, 0, 0, 0, 0, 0, 0
.short 2208, 2208, 2208, 2208, 2208, 2208, 2212, 2212, 2212, 0, 0, 0, 0, 0, 0, 0
.short 2212, 2212, 2212, 2212, 2212, 2216, 2216, 2216, 2216, 0, 0, 0, 0, 0, 0, 0
.short 2216, 2216, 2216, 2216, 2216, 2216, 2220, 2220, 2220, 0, 0, 0, 0, 0, 0, 0
.short 2220, 2220, 2220, 2220, 2220, 2224, 2224, 2224, 2224, 0, 0, 0, 0, 0, 0, 0
.short 2224, 2224, 2224, 2224, 2224, 2224, 2228, 2228, 2228, 0, 0, 0, 0, 0, 0, 0
.short 2228, 2228, 2228, 2228, 2228, 2232, 2232, 2232, 2232, 0, 0, 0, 0, 0, 0, 0
.short 2232, 2232, 2232, 2232, 2232, 2232, 2236, 2236, 2236, 0, 0, 0, 0, 0, 0, 0
.short 2236, 2236, 2236, 2236, 2236, 2240, 2240, 2240, 2240, 0, 0, 0, 0, 0, 0, 0
.short 2240, 2240, 2240, 2240, 2240, 2240, 2244, 2244, 2244, 0, 0, 0, 0, 0, 0, 0
.short 2244, 2244, 2244, 2244, 2244, 2248, 2248, 2248, 2248, 0, 0, 0, 0, 0, 0, 0
.short 2248, 2248, 2248, 2248, 2248, 2248, 2252, 2252, 2252, 0, 0, 0, 0, 0, 0, 0
.short 2252, 2252, 2252, 2252, 2252, 2256, 2256, 2256, 2256, 0, 0, 0, 0, 0, 0, 0
.short 2256, 2256, 2256, 2256, 2256, 2256, 2260, 2260, 2260, 0, 0, 0, 0, 0, 0, 0
.short 2260, 2260, 2260, 2260, 2260, 2264, 2264, 2264, 2264, 0, 0, 0, 0, 0, 0, 0
.short 2264, 2264, 2264, 2264, 2264, 2264, 2268, 2268, 2268, 0, 0, 0, 0, 0, 0, 0
.short 2268, 2268, 2268, 2268, 2268, 2272, 2272, 2272, 2272, 0, 0, 0, 0, 0, 0, 0
.short 2272, 2272, 2272, 2272, 2272, 2272, 2276, 2276, 2276, 0, 0, 0, 0, 0, 0, 0
.short 2276, 2276, 2276, 2276, 2276, 2280, 2280, 2280, 2280, 0, 0, 0, 0, 0, 0, 0
.short 2280, 2280, 2280, 2280, 2280, 2280, 2284, 2284, 2284, 0, 0, 0, 0, 0, 0, 0
.short 2284, 2284, 2284, 2284, 2284, 2288, 2288, 2288, 2288, 0, 0, 0, 0, 0, 0, 0
.short 2288, 2288, 2288, 2288, 2288, 2288, 2292, 2292, 2292, 0, 0, 0, 0, 0, 0, 0
.short 2292, 2292, 2292, 2292, 2292, 2296, 2296, 2296, 2296, 0, 0, 0, 0, 0, 0, 0
.short 2296, 2296, 2296, 2296, 2296, 2296, 2300, 2300, 2300, 0, 0, 0, 0, 0, 0, 0
.short 2300, 2300, 2300, 2300, 2300, 2304, 2304, 2304, 2304, 0, 0, 0, 0, 0, 0, 0
.short 2304, 2304, 2304, 2304, 2304, 2304, 2308, 2308, 2308, 0, 0, 0, 0, 0, 0, 0
.short 2308, 2308, 2308, 2308, 2308, 2312, 2312, 2312, 2312, 0, 0, 0, 0, 0, 0, 0
.short 2312, 2312, 2312, 2312, 2312, 2312, 2316, 2316, 2316, 0, 0, 0, 0, 0, 0, 0
.short 2316, 2316, 2316, 2316, 2316, 2320, 2320, 2320, 2320, 0, 0, 0, 0, 0, 0, 0
.short 2320, 2320, 2320, 2320, 2320, 2320, 2324, 2324, 2324, 0, 0, 0, 0, 0, 0, 0
.short 2324, 2324, 2324, 2324, 2324, 2328, 2328, 2328, 2328, 0, 0, 0, 0, 0, 0, 0
.short 2328, 2328, 2328, 2328, 2328, 2328, 2332, 2332, 2332, 0, 0, 0, 0, 0, 0, 0
.short 2332, 2332, 2332, 2332, 2332, 2336, 2336, 2336, 2336, 0, 0, 0, 0, 0, 0, 0
.short 2336, 2336, 2336, 2336, 2336, 2336, 2340, 2340, 2340, 0, 0, 0, 0, 0, 0, 0
.short 2340, 2340, 2340, 2340, 2340, 2344, 2344, 2344, 2344, 0, 0, 0, 0, 0, 0, 0
.short 2344, 2344, 2344, 2344, 2344, 2344, 2348, 2348, 2348, 0, 0, 0, 0, 0, 0, 0
.short 2348, 2348, 2348, 2348, 2348, 2352, 2352, 2352, 2352, 0, 0, 0, 0, 0, 0, 0
.short 2352, 2352, 2352, 2352, 2352, 2352, 2356, 2356, 2356, 0, 0, 0, 0, 0, 0, 0
.short 2356, 2356, 2356, 2356, 2356, 2360, 2360, 2360, 2360, 0, 0, 0, 0, 0, 0, 0
.short 2360, 2360, 2360, 2360, 2360, 2360, 2364, 2364, 2364, 0, 0, 0, 0, 0, 0, 0
.short 2364, 2364, 2364, 2364, 2364, 2368, 2368, 2368, 2368, 0, 0, 0, 0, 0, 0, 0
.short 2368, 2368, 2368, 2368, 2368, 2368, 2372, 2372, 2372, 0, 0, 0, 0, 0, 0, 0
.short 2372, 2372, 2372, 2372, 2372, 2376, 2376, 2376, 2376, 0, 0, 0, 0, 0, 0, 0
.short 2376, 2376, 2376, 2376, 2376, 2376, 2380, 2380, 2380, 0, 0, 0, 0, 0, 0, 0
.short 2380, 2380, 2380, 2380, 2380, 2384, 2384, 2384, 2384, 0, 0, 0, 0, 0, 0, 0
.short 2384, 2384, 2384, 2384, 2384, 2384, 2388, 2388, 2388, 0, 0, 0, 0, 0, 0, 0
.short 2388, 2388, 2388, 2388, 2388, 2392, 2392, 2392, 2392, 0, 0, 0, 0, 0, 0, 0
.short 2392, 2392, 2392, 2392, 2392, 2392, 2396, 2396, 2396, 0, 0, 0, 0, 0, 0, 0
.short 2396, 2396, 2396, 2396, 2396, 2400, 2400, 2400, 2400, 0, 0, 0, 0, 0, 0, 0
.short 2400, 2400, 2400, 2400, 2400, 2400, 2404, 2404, 2404, 0, 0, 0, 0, 0, 0, 0
.short 2404, 2404, 2404, 2404, 2404, 2408, 2408, 2408, 2408, 0, 0, 0, 0, 0, 0, 0
.short 2408, 2408, 2408, 2408, 2408, 2408, 2412, 2412, 2412, 0, 0, 0, 0, 0, 0, 0
.short 2412, 2412, 2412, 2412, 2412, 2416, 2416, 2416, 2416, 0, 0, 0, 0, 0, 0, 0
.short 2416, 2416, 2416, 2416, 2416, 2416, 2420, 2420, 2420, 0, 0, 0, 0, 0, 0, 0
.short 2420, 2420, 2420, 2420, 2420, 2424, 2424, 2424, 2424, 0, 0, 0, 0, 0, 0, 0
.short 2424, 2424, 2424, 2424, 2424, 2424, 2428, 2428, 2428, 0, 0, 0, 0, 0, 0, 0
.short 2428, 2428, 2428, 2428, 2428, 2432, 2432, 2432, 2432, 0, 0, 0, 0, 0, 0, 0
.short 2432, 2432, 2432, 2432, 2432, 2432, 2436, 2436, 2436, 0, 0, 0, 0, 0, 0, 0
.short 2436, 2436, 2436, 2436, 2436, 2440, 2440, 2440, 2440, 0, 0, 0, 0, 0, 0, 0
.short 2440, 2440, 2440, 2440, 2440, 2440, 2444, 2444, 2444, 0, 0, 0, 0, 0, 0, 0
.short 2444, 2444, 2444, 2444, 2444, 2448, 2448, 2448, 2448, 0, 0, 0, 0, 0, 0, 0
.short 2448, 2448, 2448, 2448, 2448, 2448, 2452, 2452, 2452, 0, 0, 0, 0, 0, 0, 0
.short 2452, 2452, 2452, 2452, 2452, 2456, 2456, 2456, 2456, 0, 0, 0, 0, 0, 0, 0
.short 2456, 2456, 2456, 2456, 2456, 2456, 2460, 2460, 2460, 0, 0, 0, 0, 0, 0, 0
.short 2460, 2460, 2460, 2460, 2460, 2464, 2464, 2464, 2464, 0, 0, 0, 0, 0, 0, 0
.short 2464, 2464, 2464, 2464, 2464, 2464, 2468, 2468, 2468, 0, 0, 0, 0, 0, 0, 0
.short 2468, 2468, 2468, 2468, 2468, 2472, 2472, 2472, 2472, 0, 0, 0, 0, 0, 0, 0
.short 2472, 2472, 2472, 2472, 2472, 2472, 2476, 2476, 2476, 0, 0, 0, 0, 0, 0, 0
.short 2476, 2476, 2476, 2476, 2476, 2480, 2480, 2480, 2480, 0, 0, 0, 0, 0, 0, 0
.short 2480, 2480, 2480, 2480, 2480, 2480, 2484, 2484, 2484, 0, 0, 0, 0, 0, 0, 0
.short 2484, 2484, 2484, 2484, 2484, 2488, 2488, 2488, 2488, 0, 0, 0, 0, 0, 0, 0
.short 2488, 2488, 2488, 2488, 2488, 2488, 2492, 2492, 2492, 0, 0, 0, 0, 0, 0, 0
.short 2492, 2492, 2492, 2492, 2492, 2496, 2496, 2496, 2496, 0, 0, 0, 0, 0, 0, 0
.short 2496, 2496, 2496, 2496, 2496, 2496, 2500, 2500, 2500, 0, 0, 0, 0, 0, 0, 0
.short 2500, 2500, 2500, 2500, 2500, 2504, 2504, 2504, 2504, 0, 0, 0, 0, 0, 0, 0
.short 2504, 2504, 2504, 2504, 2504, 2504, 2508, 2508, 2508, 0, 0, 0, 0, 0, 0, 0
.short 2508, 2508, 2508, 2508, 2508, 2512, 2512, 2512, 2512, 0, 0, 0, 0, 0, 0, 0
.short 2512, 2512, 2512, 2512, 2512, 2512, 2516, 2516, 2516, 0, 0, 0, 0, 0, 0, 0
.short 2516, 2516, 2516, 2516, 2516, 2520, 2520, 2520, 2520, 0, 0, 0, 0, 0, 0, 0
.short 2520, 2520, 2520, 2520, 2520, 2520, 2524, 2524, 2524, 0, 0, 0, 0, 0, 0, 0
.short 2524, 2524, 2524, 2524, 2524, 2528, 2528, 2528, 2528, 0, 0, 0, 0, 0, 0, 0
.short 2528, 2528, 2528, 2528, 2528, 2528, 2532, 2532, 2532, 0, 0, 0, 0, 0, 0, 0
.short 2532, 2532, 2532, 2532, 2532, 2536, 2536, 2536, 2536, 0, 0, 0, 0, 0, 0, 0
.short 2536, 2536, 2536, 2536, 2536, 2536, 2540, 2540, 2540, 0, 0, 0, 0, 0, 0, 0
.short 2540, 2540, 2540, 2540, 2540, 2544, 2544, 2544, 2544, 0, 0, 0, 0, 0, 0, 0
.short 2544, 2544, 2544, 2544, 2544, 2544, 2548, 2548, 2548, 0, 0, 0, 0, 0, 0, 0
.short 2548, 2548, 2548, 2548, 2548, 2552, 2552, 2552, 2552, 0, 0, 0, 0, 0, 0, 0
.short 2552, 2552, 2552, 2552, 2552, 2552, 2556, 2556, 2556, 0, 0, 0, 0, 0, 0, 0
.short 2556, 2556, 2556, 2556, 2556, 2560, 2560, 2560, 2560, 0, 0, 0, 0, 0, 0, 0
L_tabend:
.section .rodata,"a"
.p2align 6
.amdhsa_kernel sequential_preLN__ssm_conv_s4d__swiglu_ffn__prompt_kernel
  .amdhsa_next_free_vgpr 512
  .amdhsa_next_free_sgpr 102
  .amdhsa_accum_offset 256
  .amdhsa_group_segment_fixed_size 0
  .amdhsa_kernarg_size 112
  .amdhsa_user_sgpr_count 2
  .amdhsa_user_sgpr_kernarg_segment_ptr 1
  .amdhsa_system_sgpr_workgroup_id_x 1
.end_amdhsa_kernel
```
